```python
import torch

def _softmax(x, axis=-1):
    return torch.softmax(x, dim=axis)
def _gelu(x):
    return torch.nn.functional.gelu(x, approximate="tanh")
def _silu(x):
    return torch.nn.functional.silu(x)
def _sigmoid(x):
    return torch.sigmoid(x)
def _layernorm(x, axis=-1, eps=1e-5):
    m = x.mean(dim=axis, keepdim=True)
    v = x.var(dim=axis, keepdim=True, unbiased=False)
    return (x - m) / torch.sqrt(v + eps)
def _scatter_add(tgt, idx, src, axis=0):
    return tgt.clone().index_add_(axis, idx, src)
def _segment_sum(src, seg, n):
    out = torch.zeros((n,) + src.shape[1:], dtype=src.dtype)
    return out.index_add_(0, seg, src)
def _pad(x, pw):
    flat = tuple(v for pair in reversed(pw) for v in pair)
    return torch.nn.functional.pad(x, flat)

kernel_name = 'gated_mix__mha_block_cached__mixer_token_mlp__decode'

def setup_inputs():

    _w = (lambda a: (lambda t: t.to(torch.bfloat16) if t.is_floating_point() else t)(torch.as_tensor(a)))
    def _A_setup():
        B, Sq, D = 8, 1, 512
        H, Sk, Dh = 32, 4096, 128
        return {
            "x": _w((lambda *s: torch.randn(*s, dtype=torch.bfloat16) * 0.05)(B, Sq, D)),
            "k_cache": _w((lambda *s: torch.randn(*s, dtype=torch.bfloat16) * 6.4)(B, H, Sk, Dh)),
            "v_cache": _w((lambda *s: torch.randn(*s, dtype=torch.bfloat16) * 1.6)(B, H, Sk, Dh)),
            "wq": _w((lambda *s: torch.randn(*s, dtype=torch.bfloat16) * 6.4)(D, H * Dh) * (D ** -0.5)),
            "wo": _w((lambda *s: torch.randn(*s, dtype=torch.bfloat16) * 1.6)(H * Dh, D) * ((H * Dh) ** -0.5)),
        }
    _A_in = _A_setup()

    def _B_setup():
        B, S, D, F = 8, 1, 512, 1792
        return {
            "x": _w((lambda *s: torch.randn(*s, dtype=torch.bfloat16) * 0.05)(B, S, D)),
            "w1": _w((lambda *s: torch.randn(*s, dtype=torch.bfloat16) * 3.2)(S, F) * (S ** -0.5)),
            "b1": _w((lambda *s: torch.randn(*s, dtype=torch.bfloat16) * 3.2)(F) * 0.02),
            "w2": _w((lambda *s: torch.randn(*s, dtype=torch.bfloat16) * 0.1)(F, S) * (F ** -0.5)),
            "b2": _w((lambda *s: torch.randn(*s, dtype=torch.bfloat16) * 0.1)(S) * 0.02),
        }
    _B_in = _B_setup()

    return {
        "A_x": _A_in["x"],
        "A_k_cache": _A_in["k_cache"],
        "A_v_cache": _A_in["v_cache"],
        "A_wq": _A_in["wq"],
        "A_wo": _A_in["wo"],
        "B_x": _B_in["x"],
        "B_w1": _B_in["w1"],
        "B_b1": _B_in["b1"],
        "B_w2": _B_in["w2"],
        "B_b2": _B_in["b2"],
        "gate_w": _w((lambda *s: torch.randn(*s, dtype=torch.bfloat16) * 0.05)(512) * 16.0),
    }

def reference(A_x, A_k_cache, A_v_cache, A_wq, A_wo, B_x, B_w1, B_b1, B_w2, B_b2, gate_w):
    def _A_ref(x, k_cache, v_cache, wq, wo):
        B, Sq, D = x.shape
        H, Dh = 32, 128
        q = (lambda x, *d: x.permute(*d))((x @ wq).reshape(B, Sq, H, Dh), 0, 2, 1, 3)
        scores = torch.einsum("bhqd,bhkd->bhqk", q, k_cache) * (Dh ** -0.5)
        p = _softmax(scores, axis=-1)
        o = torch.einsum("bhqk,bhkd->bhqd", p, v_cache)
        return (lambda x, *d: x.permute(*d))(o, 0, 2, 1, 3).reshape(B, Sq, H * Dh) @ wo

    def _B_ref(x, w1, b1, w2, b2):
        B, S, D = x.shape
        h = _layernorm(x, axis=-1)
        u = torch.einsum("bsd,sf->bdf", h, w1) + b1
        u = _gelu(u)
        y = torch.einsum("bdf,fs->bds", u, w2) + b2
        return (lambda x, *d: x.permute(*d))(y, 0, 2, 1)

    x = A_x
    g = _sigmoid((x * gate_w).sum(-1, keepdims=True))
    a = _A_ref(x, A_k_cache, A_v_cache, A_wq, A_wo)
    b = _B_ref(x, B_w1, B_b1, B_w2, B_b2)
    return g * a + (1 - g) * b
```

```asm
; @launch grid=(256,1,1) block=(576,1,1) lds=155776
.amdgcn_target "amdgcn-amd-amdhsa--gfx950"
.text
.globl gated_mix__mha_block_cached__mixer_token_mlp__decode_kernel
.p2align 8
.type gated_mix__mha_block_cached__mixer_token_mlp__decode_kernel,@function
gated_mix__mha_block_cached__mixer_token_mlp__decode_kernel:
s_cmp_ge_u32 s2, 0x100
s_cbranch_scc1 L_end
s_load_dwordx16 s[16:31], s[0:1], 0
s_load_dwordx8 s[32:39], s[0:1], 64
s_load_dwordx4 s[40:43], s[0:1], 96
v_lshrrev_b32 v3, 6, v0
v_and_b32 v1, 63, v0
v_readfirstlane_b32 s3, v3
v_lshlrev_b32 v2, 4, v1
v_and_b32 v4, 15, v1
v_lshrrev_b32 v5, 4, v1
s_lshr_b32 s5, s2, 5
s_and_b32 s4, s2, 31
s_mov_b32 s66, 0xffff0000
s_mov_b32 s65, 0x3fb8aa3b
s_cmp_eq_u32 s3, 8
s_cbranch_scc1 L_helper
s_setprio 2
v_and_b32 v6, 1, v4
v_lshlrev_b32 v6, 4, v6
v_mov_b32 v7, 0xffff
v_lshlrev_b32 v6, v6, v7
v_bfe_u32 v7, v4, 1, 2
v_cmp_eq_u32 vcc, 0, v7
s_nop 1
v_cndmask_b32 v8, 0, v6, vcc
v_cmp_eq_u32 vcc, 1, v7
s_nop 1
v_cndmask_b32 v9, 0, v6, vcc
v_cmp_eq_u32 vcc, 2, v7
s_nop 1
v_cndmask_b32 v10, 0, v6, vcc
v_cmp_eq_u32 vcc, 3, v7
s_nop 1
v_cndmask_b32 v11, 0, v6, vcc
v_lshlrev_b32 v25, 17, v5
v_lshl_add_u32 v25, v4, 4, v25
v_lshlrev_b32 v26, 5, v5
v_and_b32 v27, 1, v5
v_lshlrev_b32 v27, 4, v27
v_lshl_add_u32 v27, v4, 5, v27
s_lshl_b32 s6, s2, 20
s_lshr_b32 s7, s2, 12
s_lshl_b32 s8, s5, 10
s_lshl_b32 s9, s3, 7
s_add_u32 s8, s8, s9
s_lshl_b32 s62, s3, 19
s_lshl_b32 s9, s4, 8
s_add_u32 s62, s62, s9
s_lshl_b32 s60, s3, 12
s_mov_b32 s72, s60
s_mov_b32 s46, 0x100000
s_mov_b32 s47, 0x20000
s_mov_b32 s50, 0x100000
s_mov_b32 s51, 0x20000
s_mov_b32 s54, 0x400000
s_mov_b32 s55, 0x20000
s_mov_b32 s58, 0x400000
s_mov_b32 s59, 0x20000
s_waitcnt lgkmcnt(0)
s_add_u32 s16, s16, s8
s_addc_u32 s17, s17, 0
s_mov_b32 s52, s22
s_mov_b32 s53, s23
global_load_dwordx4 v[136:139], v26, s[16:17]
global_load_dwordx4 v[140:143], v26, s[16:17] offset:16
s_add_u32 s44, s18, s6
s_addc_u32 s45, s19, s7
s_lshl_b32 s63, s3, 14
s_mov_b32 s74, 0x01000100
s_mov_b32 s75, 0x03020302
s_add_u32 m0, s63, 0
s_nop 0
buffer_load_dwordx4 v2, s[44:47], s60 offen offset:0 nt lds
buffer_load_dwordx4 v[72:75], v25, s[52:55], s62 offen nt
s_add_u32 s62, s62, 0x2000
buffer_load_dwordx4 v2, s[44:47], s60 offen offset:1024 nt lds
buffer_load_dwordx4 v[76:79], v25, s[52:55], s62 offen nt
s_add_u32 s62, s62, 0x2000
buffer_load_dwordx4 v2, s[44:47], s60 offen offset:2048 nt lds
buffer_load_dwordx4 v[80:83], v25, s[52:55], s62 offen nt
s_add_u32 s62, s62, 0x2000
buffer_load_dwordx4 v2, s[44:47], s60 offen offset:3072 nt lds
s_add_u32 s60, s60, 0x8000
s_add_u32 m0, s63, 4096
s_nop 0
buffer_load_dwordx4 v2, s[44:47], s60 offen offset:0 nt lds
buffer_load_dwordx4 v[84:87], v25, s[52:55], s62 offen nt
s_add_u32 s62, s62, 0x2000
buffer_load_dwordx4 v2, s[44:47], s60 offen offset:1024 nt lds
buffer_load_dwordx4 v[88:91], v25, s[52:55], s62 offen nt
s_add_u32 s62, s62, 0x2000
buffer_load_dwordx4 v2, s[44:47], s60 offen offset:2048 nt lds
buffer_load_dwordx4 v2, s[44:47], s60 offen offset:3072 nt lds
s_add_u32 s60, s60, 0x8000
buffer_load_dwordx4 v[92:95], v25, s[52:55], s62 offen nt
s_add_u32 s62, s62, 0x2000
s_add_u32 m0, s63, 8192
s_nop 0
buffer_load_dwordx4 v2, s[44:47], s60 offen offset:0 nt lds
buffer_load_dwordx4 v[96:99], v25, s[52:55], s62 offen nt
s_add_u32 s62, s62, 0x2000
buffer_load_dwordx4 v2, s[44:47], s60 offen offset:1024 nt lds
buffer_load_dwordx4 v2, s[44:47], s60 offen offset:2048 nt lds
buffer_load_dwordx4 v[100:103], v25, s[52:55], s62 offen nt
s_add_u32 s62, s62, 0x2000
buffer_load_dwordx4 v2, s[44:47], s60 offen offset:3072 nt lds
s_add_u32 s60, s60, 0x8000
s_waitcnt vmcnt(20)
v_perm_b32 v3, v136, v136, s74
v_and_b32 v32, v3, v8
v_and_b32 v33, v3, v9
v_and_b32 v34, v3, v10
v_and_b32 v35, v3, v11
s_waitcnt vmcnt(18)
s_nop 0
v_mfma_f32_16x16x32_bf16 v[36:39], v[32:35], v[72:75], 0
buffer_load_dwordx4 v[72:75], v25, s[52:55], s62 offen nt
s_add_u32 s62, s62, 0x2000
s_add_u32 m0, s63, 12288
s_nop 0
buffer_load_dwordx4 v2, s[44:47], s60 offen offset:0 nt lds
v_perm_b32 v3, v136, v136, s75
v_and_b32 v32, v3, v8
v_and_b32 v33, v3, v9
v_and_b32 v34, v3, v10
v_and_b32 v35, v3, v11
s_waitcnt vmcnt(18)
s_nop 0
v_mfma_f32_16x16x32_bf16 v[36:39], v[32:35], v[76:79], v[36:39]
buffer_load_dwordx4 v[76:79], v25, s[52:55], s62 offen nt
s_add_u32 s62, s62, 0x2000
buffer_load_dwordx4 v2, s[44:47], s60 offen offset:1024 nt lds
buffer_load_dwordx4 v2, s[44:47], s60 offen offset:2048 nt lds
v_perm_b32 v3, v137, v137, s74
v_and_b32 v32, v3, v8
v_and_b32 v33, v3, v9
v_and_b32 v34, v3, v10
v_and_b32 v35, v3, v11
s_waitcnt vmcnt(19)
s_nop 0
v_mfma_f32_16x16x32_bf16 v[36:39], v[32:35], v[80:83], v[36:39]
buffer_load_dwordx4 v[80:83], v25, s[52:55], s62 offen nt
s_add_u32 s62, s62, 0x2000
buffer_load_dwordx4 v2, s[44:47], s60 offen offset:3072 nt lds
s_add_u32 s60, s60, 0x8000
v_perm_b32 v3, v137, v137, s75
v_and_b32 v32, v3, v8
v_and_b32 v33, v3, v9
v_and_b32 v34, v3, v10
v_and_b32 v35, v3, v11
s_waitcnt vmcnt(18)
s_nop 0
v_mfma_f32_16x16x32_bf16 v[36:39], v[32:35], v[84:87], v[36:39]
buffer_load_dwordx4 v[84:87], v25, s[52:55], s62 offen nt
s_add_u32 s62, s62, 0x2000
buffer_load_dwordx4 v[56:59], v2, s[44:47], s60 offen offset:0 nt
buffer_load_dwordx4 v[60:63], v2, s[44:47], s60 offen offset:1024 nt
v_perm_b32 v3, v138, v138, s74
v_and_b32 v32, v3, v8
v_and_b32 v33, v3, v9
v_and_b32 v34, v3, v10
v_and_b32 v35, v3, v11
s_waitcnt vmcnt(19)
s_nop 0
v_mfma_f32_16x16x32_bf16 v[36:39], v[32:35], v[88:91], v[36:39]
buffer_load_dwordx4 v[88:91], v25, s[52:55], s62 offen nt
s_add_u32 s62, s62, 0x2000
buffer_load_dwordx4 v[64:67], v2, s[44:47], s60 offen offset:2048 nt
v_perm_b32 v3, v138, v138, s75
v_and_b32 v32, v3, v8
v_and_b32 v33, v3, v9
v_and_b32 v34, v3, v10
v_and_b32 v35, v3, v11
s_waitcnt vmcnt(18)
s_nop 0
v_mfma_f32_16x16x32_bf16 v[36:39], v[32:35], v[92:95], v[36:39]
buffer_load_dwordx4 v[92:95], v25, s[52:55], s62 offen nt
s_add_u32 s62, s62, 0x2000
buffer_load_dwordx4 v[68:71], v2, s[44:47], s60 offen offset:3072 nt
s_add_u32 s60, s60, 0x8000
buffer_load_dwordx4 v[144:147], v2, s[44:47], s60 offen offset:0 nt
v_perm_b32 v3, v139, v139, s74
v_and_b32 v32, v3, v8
v_and_b32 v33, v3, v9
v_and_b32 v34, v3, v10
v_and_b32 v35, v3, v11
s_waitcnt vmcnt(19)
s_nop 0
v_mfma_f32_16x16x32_bf16 v[36:39], v[32:35], v[96:99], v[36:39]
buffer_load_dwordx4 v[96:99], v25, s[52:55], s62 offen nt
s_add_u32 s62, s62, 0x2000
buffer_load_dwordx4 v[148:151], v2, s[44:47], s60 offen offset:1024 nt
v_perm_b32 v3, v139, v139, s75
v_and_b32 v32, v3, v8
v_and_b32 v33, v3, v9
v_and_b32 v34, v3, v10
v_and_b32 v35, v3, v11
s_waitcnt vmcnt(18)
s_nop 0
v_mfma_f32_16x16x32_bf16 v[36:39], v[32:35], v[100:103], v[36:39]
buffer_load_dwordx4 v[100:103], v25, s[52:55], s62 offen nt
buffer_load_dwordx4 v[152:155], v2, s[44:47], s60 offen offset:2048 nt
buffer_load_dwordx4 v[156:159], v2, s[44:47], s60 offen offset:3072 nt
s_add_u32 s60, s60, 0x8000
buffer_load_dwordx4 v[104:107], v2, s[44:47], s60 offen offset:0 nt
buffer_load_dwordx4 v[108:111], v2, s[44:47], s60 offen offset:1024 nt
buffer_load_dwordx4 v[112:115], v2, s[44:47], s60 offen offset:2048 nt
buffer_load_dwordx4 v[116:119], v2, s[44:47], s60 offen offset:3072 nt
s_add_u32 s60, s60, 0x8000
buffer_load_dwordx4 v[40:43], v2, s[44:47], s60 offen offset:0 nt
buffer_load_dwordx4 v[44:47], v2, s[44:47], s60 offen offset:1024 nt
buffer_load_dwordx4 v[48:51], v2, s[44:47], s60 offen offset:2048 nt
s_add_u32 s48, s20, s6
s_addc_u32 s49, s21, s7
s_mov_b32 s56, s24
s_mov_b32 s57, s25
v_perm_b32 v3, v140, v140, s74
v_and_b32 v32, v3, v8
v_and_b32 v33, v3, v9
v_and_b32 v34, v3, v10
v_and_b32 v35, v3, v11
s_waitcnt vmcnt(26)
s_nop 0
v_mfma_f32_16x16x32_bf16 v[36:39], v[32:35], v[72:75], v[36:39]
v_perm_b32 v3, v140, v140, s75
v_and_b32 v32, v3, v8
v_and_b32 v33, v3, v9
v_and_b32 v34, v3, v10
v_and_b32 v35, v3, v11
s_waitcnt vmcnt(24)
s_nop 0
v_mfma_f32_16x16x32_bf16 v[36:39], v[32:35], v[76:79], v[36:39]
v_perm_b32 v3, v141, v141, s74
v_and_b32 v32, v3, v8
v_and_b32 v33, v3, v9
v_and_b32 v34, v3, v10
v_and_b32 v35, v3, v11
s_waitcnt vmcnt(21)
s_nop 0
v_mfma_f32_16x16x32_bf16 v[36:39], v[32:35], v[80:83], v[36:39]
v_perm_b32 v3, v141, v141, s75
v_and_b32 v32, v3, v8
v_and_b32 v33, v3, v9
v_and_b32 v34, v3, v10
v_and_b32 v35, v3, v11
s_waitcnt vmcnt(19)
s_nop 0
v_mfma_f32_16x16x32_bf16 v[36:39], v[32:35], v[84:87], v[36:39]
v_perm_b32 v3, v142, v142, s74
v_and_b32 v32, v3, v8
v_and_b32 v33, v3, v9
v_and_b32 v34, v3, v10
v_and_b32 v35, v3, v11
s_waitcnt vmcnt(16)
s_nop 0
v_mfma_f32_16x16x32_bf16 v[36:39], v[32:35], v[88:91], v[36:39]
v_perm_b32 v3, v142, v142, s75
v_and_b32 v32, v3, v8
v_and_b32 v33, v3, v9
v_and_b32 v34, v3, v10
v_and_b32 v35, v3, v11
s_waitcnt vmcnt(14)
s_nop 0
v_mfma_f32_16x16x32_bf16 v[36:39], v[32:35], v[92:95], v[36:39]
v_perm_b32 v3, v143, v143, s74
v_and_b32 v32, v3, v8
v_and_b32 v33, v3, v9
v_and_b32 v34, v3, v10
v_and_b32 v35, v3, v11
s_waitcnt vmcnt(11)
s_nop 0
v_mfma_f32_16x16x32_bf16 v[36:39], v[32:35], v[96:99], v[36:39]
v_perm_b32 v3, v143, v143, s75
v_and_b32 v32, v3, v8
v_and_b32 v33, v3, v9
v_and_b32 v34, v3, v10
v_and_b32 v35, v3, v11
s_waitcnt vmcnt(9)
s_nop 0
v_mfma_f32_16x16x32_bf16 v[36:39], v[32:35], v[100:103], v[36:39]
s_lshl_b32 s6, s3, 9
s_add_u32 s7, s6, 147456
v_add_u32 v26, s7, v27
s_nop 4
ds_write_b128 v26, v[36:39]
v_lshlrev_b32 v3, 3, v1
v_add_u32 v0, 147456, v3
s_waitcnt lgkmcnt(0)
s_barrier
ds_read_b64 v[72:73], v0 offset:0
ds_read_b64 v[74:75], v0 offset:512
ds_read_b64 v[76:77], v0 offset:1024
ds_read_b64 v[78:79], v0 offset:1536
ds_read_b64 v[80:81], v0 offset:2048
ds_read_b64 v[82:83], v0 offset:2560
ds_read_b64 v[84:85], v0 offset:3072
ds_read_b64 v[86:87], v0 offset:3584
s_add_u32 s10, s6, 151552
v_lshl_add_u32 v3, v1, 2, s10
v_lshl_add_u32 v6, v4, 4, s10
s_waitcnt lgkmcnt(0)
v_add_f32 v72, v72, v74
v_add_f32 v76, v76, v78
v_add_f32 v80, v80, v82
v_add_f32 v84, v84, v86
v_add_f32 v72, v72, v76
v_add_f32 v80, v80, v84
v_add_f32 v16, v72, v80
v_add_f32 v73, v73, v75
v_add_f32 v77, v77, v79
v_add_f32 v81, v81, v83
v_add_f32 v85, v85, v87
v_add_f32 v73, v73, v77
v_add_f32 v81, v81, v85
v_add_f32 v17, v73, v81
v_cvt_pk_bf16_f32 v7, v16, v17
ds_write_b32 v3, v7
s_waitcnt lgkmcnt(0)
ds_read_b128 v[12:15], v6
s_lshl_b32 s11, s3, 11
s_add_u32 s11, s11, 131072
v_lshrrev_b32 v3, 2, v4
v_lshl_add_u32 v3, v5, 2, v3
v_lshl_add_u32 v23, v3, 2, s11
v_lshl_add_u32 v24, v5, 4, s11
s_waitcnt lgkmcnt(0)
v_add_u32 v25, s63, v2
v_mov_b32 v28, v23
v_add_u32 v23, 384, v23
s_mov_b32 s13, 0
s_mov_b32 s61, 8
L_kloop:
s_waitcnt vmcnt(1)
v_dot2_f32_bf16 v6, v40, v12, 0
v_dot2_f32_bf16 v7, v41, v13, 0
v_dot2_f32_bf16 v6, v42, v14, v6
v_dot2_f32_bf16 v7, v43, v15, v7
buffer_load_dwordx4 v[40:43], v2, s[44:47], s60 offen offset:3072 nt
s_add_u32 s60, s60, 0x8000
v_add_f32_dpp v20, v16, v16 row_ror:8 row_mask:0xf bank_mask:0x3
v_add_f32_dpp v21, v17, v17 row_ror:8 row_mask:0xf bank_mask:0x3
v_add_f32_dpp v20, v18, v18 row_ror:8 row_mask:0xf bank_mask:0xc
v_add_f32_dpp v21, v19, v19 row_ror:8 row_mask:0xf bank_mask:0xc
s_nop 0
v_add_f32_dpp v22, v20, v20 row_ror:12 row_mask:0xf bank_mask:0x5
v_add_f32_dpp v22, v21, v21 row_ror:4 row_mask:0xf bank_mask:0xa
s_nop 1
v_add_f32_dpp v22, v22, v22 quad_perm:[1,0,3,2] row_mask:0xf bank_mask:0xf
s_nop 1
v_add_f32_dpp v22, v22, v22 quad_perm:[2,3,0,1] row_mask:0xf bank_mask:0xf
ds_write_b32 v23, v22 offset:0
v_add_f32 v16, v6, v7
s_waitcnt vmcnt(1)
v_dot2_f32_bf16 v6, v44, v12, 0
v_dot2_f32_bf16 v7, v45, v13, 0
v_dot2_f32_bf16 v6, v46, v14, v6
v_dot2_f32_bf16 v7, v47, v15, v7
buffer_load_dwordx4 v[44:47], v2, s[44:47], s60 offen offset:0 nt
s_nop 1
v_add_f32 v17, v6, v7
s_waitcnt vmcnt(2)
v_dot2_f32_bf16 v6, v48, v12, 0
v_dot2_f32_bf16 v7, v49, v13, 0
v_dot2_f32_bf16 v6, v50, v14, v6
v_dot2_f32_bf16 v7, v51, v15, v7
buffer_load_dwordx4 v[48:51], v2, s[44:47], s60 offen offset:1024 nt
s_nop 1
v_add_f32 v18, v6, v7
s_waitcnt vmcnt(2)
v_dot2_f32_bf16 v6, v40, v12, 0
v_dot2_f32_bf16 v7, v41, v13, 0
v_dot2_f32_bf16 v6, v42, v14, v6
v_dot2_f32_bf16 v7, v43, v15, v7
buffer_load_dwordx4 v[40:43], v2, s[44:47], s60 offen offset:2048 nt
s_nop 1
v_add_f32 v19, v6, v7
s_waitcnt vmcnt(1)
v_dot2_f32_bf16 v6, v44, v12, 0
v_dot2_f32_bf16 v7, v45, v13, 0
v_dot2_f32_bf16 v6, v46, v14, v6
v_dot2_f32_bf16 v7, v47, v15, v7
buffer_load_dwordx4 v[44:47], v2, s[44:47], s60 offen offset:3072 nt
s_add_u32 s60, s60, 0x8000
v_add_f32_dpp v20, v16, v16 row_ror:8 row_mask:0xf bank_mask:0x3
v_add_f32_dpp v21, v17, v17 row_ror:8 row_mask:0xf bank_mask:0x3
v_add_f32_dpp v20, v18, v18 row_ror:8 row_mask:0xf bank_mask:0xc
v_add_f32_dpp v21, v19, v19 row_ror:8 row_mask:0xf bank_mask:0xc
s_nop 0
v_add_f32_dpp v22, v20, v20 row_ror:12 row_mask:0xf bank_mask:0x5
v_add_f32_dpp v22, v21, v21 row_ror:4 row_mask:0xf bank_mask:0xa
s_nop 1
v_add_f32_dpp v22, v22, v22 quad_perm:[1,0,3,2] row_mask:0xf bank_mask:0xf
s_nop 1
v_add_f32_dpp v22, v22, v22 quad_perm:[2,3,0,1] row_mask:0xf bank_mask:0xf
ds_write_b32 v23, v22 offset:64
v_add_f32 v16, v6, v7
s_waitcnt vmcnt(1)
v_dot2_f32_bf16 v6, v48, v12, 0
v_dot2_f32_bf16 v7, v49, v13, 0
v_dot2_f32_bf16 v6, v50, v14, v6
v_dot2_f32_bf16 v7, v51, v15, v7
buffer_load_dwordx4 v[48:51], v2, s[44:47], s60 offen offset:0 nt
s_nop 1
v_add_f32 v17, v6, v7
s_waitcnt vmcnt(2)
v_dot2_f32_bf16 v6, v40, v12, 0
v_dot2_f32_bf16 v7, v41, v13, 0
v_dot2_f32_bf16 v6, v42, v14, v6
v_dot2_f32_bf16 v7, v43, v15, v7
buffer_load_dwordx4 v[40:43], v2, s[44:47], s60 offen offset:1024 nt
s_nop 1
v_add_f32 v18, v6, v7
s_waitcnt vmcnt(2)
v_dot2_f32_bf16 v6, v44, v12, 0
v_dot2_f32_bf16 v7, v45, v13, 0
v_dot2_f32_bf16 v6, v46, v14, v6
v_dot2_f32_bf16 v7, v47, v15, v7
buffer_load_dwordx4 v[44:47], v2, s[44:47], s60 offen offset:2048 nt
s_nop 1
v_add_f32 v19, v6, v7
s_waitcnt vmcnt(1)
v_dot2_f32_bf16 v6, v48, v12, 0
v_dot2_f32_bf16 v7, v49, v13, 0
v_dot2_f32_bf16 v6, v50, v14, v6
v_dot2_f32_bf16 v7, v51, v15, v7
buffer_load_dwordx4 v[48:51], v2, s[44:47], s60 offen offset:3072 nt
s_add_u32 s60, s60, 0x8000
v_add_f32_dpp v20, v16, v16 row_ror:8 row_mask:0xf bank_mask:0x3
v_add_f32_dpp v21, v17, v17 row_ror:8 row_mask:0xf bank_mask:0x3
v_add_f32_dpp v20, v18, v18 row_ror:8 row_mask:0xf bank_mask:0xc
v_add_f32_dpp v21, v19, v19 row_ror:8 row_mask:0xf bank_mask:0xc
s_nop 0
v_add_f32_dpp v22, v20, v20 row_ror:12 row_mask:0xf bank_mask:0x5
v_add_f32_dpp v22, v21, v21 row_ror:4 row_mask:0xf bank_mask:0xa
s_nop 1
v_add_f32_dpp v22, v22, v22 quad_perm:[1,0,3,2] row_mask:0xf bank_mask:0xf
s_nop 1
v_add_f32_dpp v22, v22, v22 quad_perm:[2,3,0,1] row_mask:0xf bank_mask:0xf
ds_write_b32 v23, v22 offset:128
v_add_f32 v16, v6, v7
s_waitcnt vmcnt(1)
v_dot2_f32_bf16 v6, v40, v12, 0
v_dot2_f32_bf16 v7, v41, v13, 0
v_dot2_f32_bf16 v6, v42, v14, v6
v_dot2_f32_bf16 v7, v43, v15, v7
buffer_load_dwordx4 v[40:43], v2, s[44:47], s60 offen offset:0 nt
s_nop 1
v_add_f32 v17, v6, v7
s_waitcnt vmcnt(2)
v_dot2_f32_bf16 v6, v44, v12, 0
v_dot2_f32_bf16 v7, v45, v13, 0
v_dot2_f32_bf16 v6, v46, v14, v6
v_dot2_f32_bf16 v7, v47, v15, v7
buffer_load_dwordx4 v[44:47], v2, s[44:47], s60 offen offset:1024 nt
s_nop 1
v_add_f32 v18, v6, v7
s_waitcnt vmcnt(2)
v_dot2_f32_bf16 v6, v48, v12, 0
v_dot2_f32_bf16 v7, v49, v13, 0
v_dot2_f32_bf16 v6, v50, v14, v6
v_dot2_f32_bf16 v7, v51, v15, v7
buffer_load_dwordx4 v[48:51], v2, s[44:47], s60 offen offset:2048 nt
s_nop 1
v_add_f32 v19, v6, v7
s_cmp_ge_u32 s13, 7
s_cbranch_scc1 L_nostage
s_cmp_lg_u32 s13, 4
s_cbranch_scc1 L_nors0
v_dot2_f32_bf16 v164, v56, v12, 0
v_dot2_f32_bf16 v164, v57, v13, v164
v_dot2_f32_bf16 v164, v58, v14, v164
v_dot2_f32_bf16 v164, v59, v15, v164
v_dot2_f32_bf16 v165, v60, v12, 0
v_dot2_f32_bf16 v165, v61, v13, v165
v_dot2_f32_bf16 v165, v62, v14, v165
v_dot2_f32_bf16 v165, v63, v15, v165
v_dot2_f32_bf16 v166, v64, v12, 0
v_dot2_f32_bf16 v166, v65, v13, v166
v_dot2_f32_bf16 v166, v66, v14, v166
v_dot2_f32_bf16 v166, v67, v15, v166
v_dot2_f32_bf16 v167, v68, v12, 0
v_dot2_f32_bf16 v167, v69, v13, v167
v_dot2_f32_bf16 v167, v70, v14, v167
v_dot2_f32_bf16 v167, v71, v15, v167
s_branch L_sred
L_nors0:
s_cmp_lg_u32 s13, 5
s_cbranch_scc1 L_nors1
v_dot2_f32_bf16 v164, v144, v12, 0
v_dot2_f32_bf16 v164, v145, v13, v164
v_dot2_f32_bf16 v164, v146, v14, v164
v_dot2_f32_bf16 v164, v147, v15, v164
v_dot2_f32_bf16 v165, v148, v12, 0
v_dot2_f32_bf16 v165, v149, v13, v165
v_dot2_f32_bf16 v165, v150, v14, v165
v_dot2_f32_bf16 v165, v151, v15, v165
v_dot2_f32_bf16 v166, v152, v12, 0
v_dot2_f32_bf16 v166, v153, v13, v166
v_dot2_f32_bf16 v166, v154, v14, v166
v_dot2_f32_bf16 v166, v155, v15, v166
v_dot2_f32_bf16 v167, v156, v12, 0
v_dot2_f32_bf16 v167, v157, v13, v167
v_dot2_f32_bf16 v167, v158, v14, v167
v_dot2_f32_bf16 v167, v159, v15, v167
s_branch L_sred
L_nors1:
s_cmp_lg_u32 s13, 6
s_cbranch_scc1 L_nors2
v_dot2_f32_bf16 v164, v104, v12, 0
v_dot2_f32_bf16 v164, v105, v13, v164
v_dot2_f32_bf16 v164, v106, v14, v164
v_dot2_f32_bf16 v164, v107, v15, v164
v_dot2_f32_bf16 v165, v108, v12, 0
v_dot2_f32_bf16 v165, v109, v13, v165
v_dot2_f32_bf16 v165, v110, v14, v165
v_dot2_f32_bf16 v165, v111, v15, v165
v_dot2_f32_bf16 v166, v112, v12, 0
v_dot2_f32_bf16 v166, v113, v13, v166
v_dot2_f32_bf16 v166, v114, v14, v166
v_dot2_f32_bf16 v166, v115, v15, v166
v_dot2_f32_bf16 v167, v116, v12, 0
v_dot2_f32_bf16 v167, v117, v13, v167
v_dot2_f32_bf16 v167, v118, v14, v167
v_dot2_f32_bf16 v167, v119, v15, v167
s_branch L_sred
L_nors2:
ds_read_b128 v[72:75], v25 offset:0
ds_read_b128 v[76:79], v25 offset:1024
ds_read_b128 v[80:83], v25 offset:2048
ds_read_b128 v[84:87], v25 offset:3072
v_add_u32 v25, 0x1000, v25
s_waitcnt lgkmcnt(3)
v_dot2_f32_bf16 v164, v72, v12, 0
v_dot2_f32_bf16 v164, v73, v13, v164
v_dot2_f32_bf16 v164, v74, v14, v164
v_dot2_f32_bf16 v164, v75, v15, v164
s_waitcnt lgkmcnt(2)
v_dot2_f32_bf16 v165, v76, v12, 0
v_dot2_f32_bf16 v165, v77, v13, v165
v_dot2_f32_bf16 v165, v78, v14, v165
v_dot2_f32_bf16 v165, v79, v15, v165
s_waitcnt lgkmcnt(1)
v_dot2_f32_bf16 v166, v80, v12, 0
v_dot2_f32_bf16 v166, v81, v13, v166
v_dot2_f32_bf16 v166, v82, v14, v166
v_dot2_f32_bf16 v166, v83, v15, v166
s_waitcnt lgkmcnt(0)
v_dot2_f32_bf16 v167, v84, v12, 0
v_dot2_f32_bf16 v167, v85, v13, v167
v_dot2_f32_bf16 v167, v86, v14, v167
v_dot2_f32_bf16 v167, v87, v15, v167
L_sred:
s_add_u32 s13, s13, 1
v_add_f32_dpp v20, v164, v164 row_ror:8 row_mask:0xf bank_mask:0x3
v_add_f32_dpp v21, v165, v165 row_ror:8 row_mask:0xf bank_mask:0x3
v_add_f32_dpp v20, v166, v166 row_ror:8 row_mask:0xf bank_mask:0xc
v_add_f32_dpp v21, v167, v167 row_ror:8 row_mask:0xf bank_mask:0xc
s_nop 0
v_add_f32_dpp v22, v20, v20 row_ror:12 row_mask:0xf bank_mask:0x5
v_add_f32_dpp v22, v21, v21 row_ror:4 row_mask:0xf bank_mask:0xa
s_nop 1
v_add_f32_dpp v22, v22, v22 quad_perm:[1,0,3,2] row_mask:0xf bank_mask:0xf
s_nop 1
v_add_f32_dpp v22, v22, v22 quad_perm:[2,3,0,1] row_mask:0xf bank_mask:0xf
ds_write_b32 v28, v22 offset:0
v_add_u32 v28, 64, v28
L_nostage:
v_add_u32 v23, 192, v23
s_sub_u32 s61, s61, 1
s_cmp_lg_u32 s61, 0
s_cbranch_scc1 L_kloop
s_waitcnt vmcnt(2)
v_dot2_f32_bf16 v6, v40, v12, 0
v_dot2_f32_bf16 v7, v41, v13, 0
v_dot2_f32_bf16 v6, v42, v14, v6
v_dot2_f32_bf16 v7, v43, v15, v7
buffer_load_dwordx4 v[40:43], v2, s[44:47], s60 offen offset:3072 nt
s_add_u32 s60, s60, 0x8000
s_mov_b32 s60, s72
buffer_load_dwordx4 v[88:91], v2, s[48:51], s60 offen offset:0 nt
buffer_load_dwordx4 v[92:95], v2, s[48:51], s60 offen offset:1024 nt
buffer_load_dwordx4 v[96:99], v2, s[48:51], s60 offen offset:2048 nt
buffer_load_dwordx4 v[100:103], v2, s[48:51], s60 offen offset:3072 nt
s_add_u32 s60, s60, 0x8000
v_add_f32_dpp v20, v16, v16 row_ror:8 row_mask:0xf bank_mask:0x3
v_add_f32_dpp v21, v17, v17 row_ror:8 row_mask:0xf bank_mask:0x3
v_add_f32_dpp v20, v18, v18 row_ror:8 row_mask:0xf bank_mask:0xc
v_add_f32_dpp v21, v19, v19 row_ror:8 row_mask:0xf bank_mask:0xc
s_nop 0
v_add_f32_dpp v22, v20, v20 row_ror:12 row_mask:0xf bank_mask:0x5
v_add_f32_dpp v22, v21, v21 row_ror:4 row_mask:0xf bank_mask:0xa
s_nop 1
v_add_f32_dpp v22, v22, v22 quad_perm:[1,0,3,2] row_mask:0xf bank_mask:0xf
s_nop 1
v_add_f32_dpp v22, v22, v22 quad_perm:[2,3,0,1] row_mask:0xf bank_mask:0xf
ds_write_b32 v23, v22 offset:0
v_add_f32 v16, v6, v7
s_waitcnt vmcnt(6)
v_dot2_f32_bf16 v6, v44, v12, 0
v_dot2_f32_bf16 v7, v45, v13, 0
v_dot2_f32_bf16 v6, v46, v14, v6
v_dot2_f32_bf16 v7, v47, v15, v7
buffer_load_dwordx4 v[44:47], v2, s[48:51], s60 offen offset:0 nt
s_nop 1
v_add_f32 v17, v6, v7
s_waitcnt vmcnt(6)
v_dot2_f32_bf16 v6, v48, v12, 0
v_dot2_f32_bf16 v7, v49, v13, 0
v_dot2_f32_bf16 v6, v50, v14, v6
v_dot2_f32_bf16 v7, v51, v15, v7
buffer_load_dwordx4 v[48:51], v2, s[48:51], s60 offen offset:1024 nt
s_nop 1
v_add_f32 v18, v6, v7
s_waitcnt vmcnt(6)
v_dot2_f32_bf16 v6, v40, v12, 0
v_dot2_f32_bf16 v7, v41, v13, 0
v_dot2_f32_bf16 v6, v42, v14, v6
v_dot2_f32_bf16 v7, v43, v15, v7
buffer_load_dwordx4 v[40:43], v2, s[48:51], s60 offen offset:2048 nt
s_nop 1
v_add_f32 v19, v6, v7
v_add_f32_dpp v20, v16, v16 row_ror:8 row_mask:0xf bank_mask:0x3
v_add_f32_dpp v21, v17, v17 row_ror:8 row_mask:0xf bank_mask:0x3
v_add_f32_dpp v20, v18, v18 row_ror:8 row_mask:0xf bank_mask:0xc
v_add_f32_dpp v21, v19, v19 row_ror:8 row_mask:0xf bank_mask:0xc
s_nop 0
v_add_f32_dpp v22, v20, v20 row_ror:12 row_mask:0xf bank_mask:0x5
v_add_f32_dpp v22, v21, v21 row_ror:4 row_mask:0xf bank_mask:0xa
s_nop 1
v_add_f32_dpp v22, v22, v22 quad_perm:[1,0,3,2] row_mask:0xf bank_mask:0xf
s_nop 1
v_add_f32_dpp v22, v22, v22 quad_perm:[2,3,0,1] row_mask:0xf bank_mask:0xf
ds_write_b32 v23, v22 offset:64
s_mov_b32 s64, 0x3db504f3
v_lshl_add_u32 v3, v1, 5, s11
s_waitcnt lgkmcnt(0)
ds_read_b128 v[72:75], v3
ds_read_b128 v[76:79], v3 offset:16
s_lshl_b32 s6, s3, 2
s_add_u32 s6, s6, 155648
v_mov_b32 v6, s6
v_mov_b32 v7, 155648
s_waitcnt lgkmcnt(0)
v_cvt_pk_bf16_f32 v16, v72, v73
v_lshlrev_b32 v72, 16, v16
v_and_b32 v73, s66, v16
v_cvt_pk_bf16_f32 v17, v74, v75
v_lshlrev_b32 v74, 16, v17
v_and_b32 v75, s66, v17
v_cvt_pk_bf16_f32 v18, v76, v77
v_lshlrev_b32 v76, 16, v18
v_and_b32 v77, s66, v18
v_cvt_pk_bf16_f32 v19, v78, v79
v_lshlrev_b32 v78, 16, v19
v_and_b32 v79, s66, v19
v_mul_f32 v72, s64, v72
v_mul_f32 v73, s64, v73
v_mul_f32 v74, s64, v74
v_mul_f32 v75, s64, v75
v_mul_f32 v76, s64, v76
v_mul_f32 v77, s64, v77
v_mul_f32 v78, s64, v78
v_mul_f32 v79, s64, v79
v_cvt_pk_bf16_f32 v16, v72, v73
v_lshlrev_b32 v72, 16, v16
v_and_b32 v73, s66, v16
v_cvt_pk_bf16_f32 v17, v74, v75
v_lshlrev_b32 v74, 16, v17
v_and_b32 v75, s66, v17
v_cvt_pk_bf16_f32 v18, v76, v77
v_lshlrev_b32 v76, 16, v18
v_and_b32 v77, s66, v18
v_cvt_pk_bf16_f32 v19, v78, v79
v_lshlrev_b32 v78, 16, v19
v_and_b32 v79, s66, v19
v_max3_f32 v20, v72, v73, v74
v_max3_f32 v21, v75, v76, v77
v_max3_f32 v20, v20, v78, v79
v_max_f32 v20, v20, v21
s_nop 1
v_max_f32_dpp v20, v20, v20 row_ror:8 row_mask:0xf bank_mask:0xf
s_nop 1
v_max_f32_dpp v20, v20, v20 row_ror:4 row_mask:0xf bank_mask:0xf
s_nop 1
v_max_f32_dpp v20, v20, v20 row_ror:2 row_mask:0xf bank_mask:0xf
s_nop 1
v_max_f32_dpp v20, v20, v20 row_ror:1 row_mask:0xf bank_mask:0xf
v_mov_b32 v21, v20
s_nop 1
v_permlane16_swap_b32 v20, v21
v_max_f32 v20, v20, v21
v_mov_b32 v21, v20
s_nop 1
v_permlane32_swap_b32 v20, v21
v_max_f32 v20, v20, v21
s_mov_b64 exec, 1
ds_write_b32 v6, v20
s_mov_b64 exec, -1
s_waitcnt lgkmcnt(0)
s_barrier
ds_read_b128 v[80:83], v7
ds_read_b128 v[84:87], v7 offset:16
s_waitcnt lgkmcnt(0)
v_max3_f32 v20, v80, v81, v82
v_max3_f32 v21, v83, v84, v85
v_max3_f32 v20, v20, v86, v87
v_max_f32 v20, v20, v21
v_sub_f32 v72, v72, v20
v_sub_f32 v73, v73, v20
v_sub_f32 v74, v74, v20
v_sub_f32 v75, v75, v20
v_sub_f32 v76, v76, v20
v_sub_f32 v77, v77, v20
v_sub_f32 v78, v78, v20
v_sub_f32 v79, v79, v20
v_mul_f32 v72, s65, v72
v_mul_f32 v73, s65, v73
v_mul_f32 v74, s65, v74
v_mul_f32 v75, s65, v75
v_mul_f32 v76, s65, v76
v_mul_f32 v77, s65, v77
v_mul_f32 v78, s65, v78
v_mul_f32 v79, s65, v79
v_exp_f32 v72, v72
v_exp_f32 v73, v73
v_exp_f32 v74, v74
v_exp_f32 v75, v75
v_exp_f32 v76, v76
v_exp_f32 v77, v77
v_exp_f32 v78, v78
v_exp_f32 v79, v79
v_add_f32 v20, v72, v73
v_add_f32 v21, v74, v75
v_add_f32 v22, v76, v77
v_add_f32 v16, v78, v79
v_add_f32 v20, v20, v21
v_add_f32 v22, v22, v16
v_add_f32 v20, v20, v22
s_nop 1
v_add_f32_dpp v20, v20, v20 row_ror:8 row_mask:0xf bank_mask:0xf
s_nop 1
v_add_f32_dpp v20, v20, v20 row_ror:4 row_mask:0xf bank_mask:0xf
s_nop 1
v_add_f32_dpp v20, v20, v20 row_ror:2 row_mask:0xf bank_mask:0xf
s_nop 1
v_add_f32_dpp v20, v20, v20 row_ror:1 row_mask:0xf bank_mask:0xf
v_mov_b32 v21, v20
s_nop 1
v_permlane16_swap_b32 v20, v21
v_add_f32 v20, v20, v21
v_mov_b32 v21, v20
s_nop 1
v_permlane32_swap_b32 v20, v21
v_add_f32 v20, v20, v21
s_mov_b64 exec, 1
ds_write_b32 v6, v20 offset:32
s_mov_b64 exec, -1
s_waitcnt lgkmcnt(0)
s_barrier
ds_read_b128 v[80:83], v7 offset:32
ds_read_b128 v[84:87], v7 offset:48
s_waitcnt lgkmcnt(0)
v_add_f32 v80, v80, v81
v_add_f32 v82, v82, v83
v_add_f32 v84, v84, v85
v_add_f32 v86, v86, v87
v_add_f32 v80, v80, v82
v_add_f32 v84, v84, v86
v_add_f32 v20, v80, v84
v_rcp_f32 v20, v20
s_nop 0
v_mul_f32 v72, v72, v20
v_mul_f32 v73, v73, v20
v_mul_f32 v74, v74, v20
v_mul_f32 v75, v75, v20
v_mul_f32 v76, v76, v20
v_mul_f32 v77, v77, v20
v_mul_f32 v78, v78, v20
v_mul_f32 v79, v79, v20
v_cvt_pk_bf16_f32 v72, v72, v72
v_cvt_pk_bf16_f32 v73, v73, v73
v_cvt_pk_bf16_f32 v74, v74, v74
v_cvt_pk_bf16_f32 v75, v75, v75
v_cvt_pk_bf16_f32 v76, v76, v76
v_cvt_pk_bf16_f32 v77, v77, v77
v_cvt_pk_bf16_f32 v78, v78, v78
v_cvt_pk_bf16_f32 v79, v79, v79
ds_write_b128 v3, v[72:75]
ds_write_b128 v3, v[76:79] offset:16
v_lshrrev_b32 v6, 3, v4
v_lshl_add_u32 v6, v5, 1, v6
v_lshlrev_b32 v6, 10, v6
v_and_b32 v7, 7, v4
v_lshl_add_u32 v25, v7, 4, v6
s_lshl_b32 s62, s4, 17
s_lshl_b32 s6, s3, 7
s_add_u32 s62, s62, s6
s_lshl_b32 s63, s3, 14
s_add_u32 s12, s63, 16384
v_mov_b32 v36, 0
v_mov_b32 v37, 0
v_mov_b32 v38, 0
v_mov_b32 v39, 0
s_waitcnt lgkmcnt(0)
ds_read_b128 v[28:31], v24
s_waitcnt lgkmcnt(0)
v_and_b32 v32, v28, v8
v_and_b32 v33, v28, v9
v_and_b32 v34, v28, v10
v_and_b32 v35, v28, v11
s_waitcnt vmcnt(6)
s_nop 0
v_mfma_f32_16x16x32_bf16 v[36:39], v[32:35], v[88:91], v[36:39]
v_and_b32 v32, v29, v8
v_and_b32 v33, v29, v9
v_and_b32 v34, v29, v10
v_and_b32 v35, v29, v11
s_waitcnt vmcnt(5)
s_nop 0
v_mfma_f32_16x16x32_bf16 v[36:39], v[32:35], v[92:95], v[36:39]
v_and_b32 v32, v30, v8
v_and_b32 v33, v30, v9
v_and_b32 v34, v30, v10
v_and_b32 v35, v30, v11
s_waitcnt vmcnt(4)
s_nop 0
v_mfma_f32_16x16x32_bf16 v[36:39], v[32:35], v[96:99], v[36:39]
v_and_b32 v32, v31, v8
v_and_b32 v33, v31, v9
v_and_b32 v34, v31, v10
v_and_b32 v35, v31, v11
ds_read_b128 v[28:31], v24 offset:64
s_waitcnt vmcnt(3)
v_mfma_f32_16x16x32_bf16 v[36:39], v[32:35], v[100:103], v[36:39]
v_add_u32 v24, 64, v24
s_mov_b32 s61, 9
L_vloop:
s_waitcnt lgkmcnt(0)
v_and_b32 v32, v28, v8
v_and_b32 v33, v28, v9
v_and_b32 v34, v28, v10
v_and_b32 v35, v28, v11
s_waitcnt vmcnt(2)
s_nop 0
v_mfma_f32_16x16x32_bf16 v[36:39], v[32:35], v[44:47], v[36:39]
buffer_load_dwordx4 v[44:47], v2, s[48:51], s60 offen offset:3072 nt
s_add_u32 s60, s60, 0x8000
v_and_b32 v32, v29, v8
v_and_b32 v33, v29, v9
v_and_b32 v34, v29, v10
v_and_b32 v35, v29, v11
s_waitcnt vmcnt(2)
s_nop 0
v_mfma_f32_16x16x32_bf16 v[36:39], v[32:35], v[48:51], v[36:39]
buffer_load_dwordx4 v[48:51], v2, s[48:51], s60 offen offset:0 nt
v_and_b32 v32, v30, v8
v_and_b32 v33, v30, v9
v_and_b32 v34, v30, v10
v_and_b32 v35, v30, v11
s_waitcnt vmcnt(2)
s_nop 0
v_mfma_f32_16x16x32_bf16 v[36:39], v[32:35], v[40:43], v[36:39]
buffer_load_dwordx4 v[40:43], v2, s[48:51], s60 offen offset:1024 nt
v_and_b32 v32, v31, v8
v_and_b32 v33, v31, v9
v_and_b32 v34, v31, v10
v_and_b32 v35, v31, v11
ds_read_b128 v[28:31], v24 offset:64
s_waitcnt vmcnt(2)
v_mfma_f32_16x16x32_bf16 v[36:39], v[32:35], v[44:47], v[36:39]
buffer_load_dwordx4 v[44:47], v2, s[48:51], s60 offen offset:2048 nt
s_cmp_ge_u32 s63, s12
s_cbranch_scc1 L_nodma1
s_mov_b32 m0, s63
s_add_u32 s63, s63, 0x400
buffer_load_dwordx4 v25, s[56:59], s62 offen lds
s_add_u32 s62, s62, 0x2000
L_nodma1:
s_waitcnt lgkmcnt(0)
v_and_b32 v32, v28, v8
v_and_b32 v33, v28, v9
v_and_b32 v34, v28, v10
v_and_b32 v35, v28, v11
s_waitcnt vmcnt(2)
s_nop 0
v_mfma_f32_16x16x32_bf16 v[36:39], v[32:35], v[48:51], v[36:39]
buffer_load_dwordx4 v[48:51], v2, s[48:51], s60 offen offset:3072 nt
s_add_u32 s60, s60, 0x8000
v_and_b32 v32, v29, v8
v_and_b32 v33, v29, v9
v_and_b32 v34, v29, v10
v_and_b32 v35, v29, v11
s_waitcnt vmcnt(2)
s_nop 0
v_mfma_f32_16x16x32_bf16 v[36:39], v[32:35], v[40:43], v[36:39]
buffer_load_dwordx4 v[40:43], v2, s[48:51], s60 offen offset:0 nt
v_and_b32 v32, v30, v8
v_and_b32 v33, v30, v9
v_and_b32 v34, v30, v10
v_and_b32 v35, v30, v11
s_waitcnt vmcnt(2)
s_nop 0
v_mfma_f32_16x16x32_bf16 v[36:39], v[32:35], v[44:47], v[36:39]
buffer_load_dwordx4 v[44:47], v2, s[48:51], s60 offen offset:1024 nt
v_and_b32 v32, v31, v8
v_and_b32 v33, v31, v9
v_and_b32 v34, v31, v10
v_and_b32 v35, v31, v11
ds_read_b128 v[28:31], v24 offset:128
s_waitcnt vmcnt(2)
v_mfma_f32_16x16x32_bf16 v[36:39], v[32:35], v[48:51], v[36:39]
buffer_load_dwordx4 v[48:51], v2, s[48:51], s60 offen offset:2048 nt
s_cmp_ge_u32 s63, s12
s_cbranch_scc1 L_nodma2
s_mov_b32 m0, s63
s_add_u32 s63, s63, 0x400
buffer_load_dwordx4 v25, s[56:59], s62 offen lds
s_add_u32 s62, s62, 0x2000
L_nodma2:
s_waitcnt lgkmcnt(0)
v_and_b32 v32, v28, v8
v_and_b32 v33, v28, v9
v_and_b32 v34, v28, v10
v_and_b32 v35, v28, v11
s_waitcnt vmcnt(2)
s_nop 0
v_mfma_f32_16x16x32_bf16 v[36:39], v[32:35], v[40:43], v[36:39]
buffer_load_dwordx4 v[40:43], v2, s[48:51], s60 offen offset:3072 nt
s_add_u32 s60, s60, 0x8000
v_and_b32 v32, v29, v8
v_and_b32 v33, v29, v9
v_and_b32 v34, v29, v10
v_and_b32 v35, v29, v11
s_waitcnt vmcnt(2)
s_nop 0
v_mfma_f32_16x16x32_bf16 v[36:39], v[32:35], v[44:47], v[36:39]
buffer_load_dwordx4 v[44:47], v2, s[48:51], s60 offen offset:0 nt
v_and_b32 v32, v30, v8
v_and_b32 v33, v30, v9
v_and_b32 v34, v30, v10
v_and_b32 v35, v30, v11
s_waitcnt vmcnt(2)
s_nop 0
v_mfma_f32_16x16x32_bf16 v[36:39], v[32:35], v[48:51], v[36:39]
buffer_load_dwordx4 v[48:51], v2, s[48:51], s60 offen offset:1024 nt
v_and_b32 v32, v31, v8
v_and_b32 v33, v31, v9
v_and_b32 v34, v31, v10
v_and_b32 v35, v31, v11
ds_read_b128 v[28:31], v24 offset:192
s_waitcnt vmcnt(2)
v_mfma_f32_16x16x32_bf16 v[36:39], v[32:35], v[40:43], v[36:39]
buffer_load_dwordx4 v[40:43], v2, s[48:51], s60 offen offset:2048 nt
s_cmp_ge_u32 s63, s12
s_cbranch_scc1 L_nodma3
s_mov_b32 m0, s63
s_add_u32 s63, s63, 0x400
buffer_load_dwordx4 v25, s[56:59], s62 offen lds
s_add_u32 s62, s62, 0x2000
L_nodma3:
v_add_u32 v24, 192, v24
s_sub_u32 s61, s61, 1
s_cmp_lg_u32 s61, 0
s_cbranch_scc1 L_vloop
s_lshl_b32 s63, s3, 14
v_bfe_u32 v6, v1, 2, 2
v_lshlrev_b32 v6, 7, v6
v_lshl_add_u32 v6, v5, 10, v6
v_and_b32 v7, 3, v1
v_lshl_add_u32 v6, v7, 3, v6
v_add_u32 v25, s63, v6
s_waitcnt lgkmcnt(0)
v_and_b32 v32, v28, v8
v_and_b32 v33, v28, v9
v_and_b32 v34, v28, v10
v_and_b32 v35, v28, v11
s_waitcnt vmcnt(2)
s_nop 0
v_mfma_f32_16x16x32_bf16 v[36:39], v[32:35], v[44:47], v[36:39]
buffer_load_dwordx4 v[44:47], v2, s[48:51], s60 offen offset:3072 nt
s_add_u32 s60, s60, 0x8000
v_and_b32 v32, v29, v8
v_and_b32 v33, v29, v9
v_and_b32 v34, v29, v10
v_and_b32 v35, v29, v11
s_waitcnt vmcnt(2)
s_nop 0
v_mfma_f32_16x16x32_bf16 v[36:39], v[32:35], v[48:51], v[36:39]
buffer_load_dwordx4 v[48:51], v2, s[48:51], s60 offen offset:0 nt
v_and_b32 v32, v30, v8
v_and_b32 v33, v30, v9
v_and_b32 v34, v30, v10
v_and_b32 v35, v30, v11
s_waitcnt vmcnt(2)
s_nop 0
v_mfma_f32_16x16x32_bf16 v[36:39], v[32:35], v[40:43], v[36:39]
buffer_load_dwordx4 v[40:43], v2, s[48:51], s60 offen offset:1024 nt
v_and_b32 v32, v31, v8
v_and_b32 v33, v31, v9
v_and_b32 v34, v31, v10
v_and_b32 v35, v31, v11
ds_read_b128 v[28:31], v24 offset:64
s_waitcnt vmcnt(2)
v_mfma_f32_16x16x32_bf16 v[36:39], v[32:35], v[44:47], v[36:39]
buffer_load_dwordx4 v[44:47], v2, s[48:51], s60 offen offset:2048 nt
s_waitcnt lgkmcnt(0)
v_and_b32 v32, v28, v8
v_and_b32 v33, v28, v9
v_and_b32 v34, v28, v10
v_and_b32 v35, v28, v11
s_waitcnt vmcnt(2)
s_nop 0
v_mfma_f32_16x16x32_bf16 v[36:39], v[32:35], v[48:51], v[36:39]
buffer_load_dwordx4 v[48:51], v2, s[48:51], s60 offen offset:3072 nt
s_add_u32 s60, s60, 0x8000
buffer_load_dwordx4 v[56:59], v2, s[48:51], s60 offen offset:0 nt
buffer_load_dwordx4 v[60:63], v2, s[48:51], s60 offen offset:1024 nt
buffer_load_dwordx4 v[64:67], v2, s[48:51], s60 offen offset:2048 nt
buffer_load_dwordx4 v[68:71], v2, s[48:51], s60 offen offset:3072 nt
s_add_u32 s60, s60, 0x8000
buffer_load_dwordx4 v[144:147], v2, s[48:51], s60 offen offset:0 nt
buffer_load_dwordx4 v[148:151], v2, s[48:51], s60 offen offset:1024 nt
buffer_load_dwordx4 v[152:155], v2, s[48:51], s60 offen offset:2048 nt
buffer_load_dwordx4 v[156:159], v2, s[48:51], s60 offen offset:3072 nt
ds_read_b64_tr_b16 v[72:73], v25 offset:0
ds_read_b64_tr_b16 v[74:75], v25 offset:512
ds_read_b64_tr_b16 v[76:77], v25 offset:32
ds_read_b64_tr_b16 v[78:79], v25 offset:544
ds_read_b64_tr_b16 v[80:81], v25 offset:64
ds_read_b64_tr_b16 v[82:83], v25 offset:576
ds_read_b64_tr_b16 v[84:85], v25 offset:96
ds_read_b64_tr_b16 v[86:87], v25 offset:608
ds_read_b64_tr_b16 v[88:89], v25 offset:4096
ds_read_b64_tr_b16 v[90:91], v25 offset:4608
ds_read_b64_tr_b16 v[92:93], v25 offset:4128
ds_read_b64_tr_b16 v[94:95], v25 offset:4640
ds_read_b64_tr_b16 v[96:97], v25 offset:4160
ds_read_b64_tr_b16 v[98:99], v25 offset:4672
ds_read_b64_tr_b16 v[100:101], v25 offset:4192
s_waitcnt lgkmcnt(14)
ds_read_b64_tr_b16 v[102:103], v25 offset:4704
s_waitcnt lgkmcnt(14)
ds_read_b64_tr_b16 v[104:105], v25 offset:8192
s_waitcnt lgkmcnt(14)
ds_read_b64_tr_b16 v[106:107], v25 offset:8704
s_waitcnt lgkmcnt(14)
ds_read_b64_tr_b16 v[108:109], v25 offset:8224
s_waitcnt lgkmcnt(14)
ds_read_b64_tr_b16 v[110:111], v25 offset:8736
s_waitcnt lgkmcnt(14)
ds_read_b64_tr_b16 v[112:113], v25 offset:8256
s_waitcnt lgkmcnt(14)
ds_read_b64_tr_b16 v[114:115], v25 offset:8768
s_waitcnt lgkmcnt(14)
ds_read_b64_tr_b16 v[116:117], v25 offset:8288
s_waitcnt lgkmcnt(14)
ds_read_b64_tr_b16 v[118:119], v25 offset:8800
s_waitcnt lgkmcnt(14)
ds_read_b64_tr_b16 v[120:121], v25 offset:12288
s_waitcnt lgkmcnt(14)
ds_read_b64_tr_b16 v[122:123], v25 offset:12800
s_waitcnt lgkmcnt(14)
ds_read_b64_tr_b16 v[124:125], v25 offset:12320
s_waitcnt lgkmcnt(14)
ds_read_b64_tr_b16 v[126:127], v25 offset:12832
s_waitcnt lgkmcnt(14)
ds_read_b64_tr_b16 v[128:129], v25 offset:12352
s_waitcnt lgkmcnt(14)
ds_read_b64_tr_b16 v[130:131], v25 offset:12864
s_waitcnt lgkmcnt(14)
ds_read_b64_tr_b16 v[132:133], v25 offset:12384
s_waitcnt lgkmcnt(14)
ds_read_b64_tr_b16 v[134:135], v25 offset:12896
v_and_b32 v32, v29, v8
v_and_b32 v33, v29, v9
v_and_b32 v34, v29, v10
v_and_b32 v35, v29, v11
s_waitcnt vmcnt(10)
s_nop 0
v_mfma_f32_16x16x32_bf16 v[36:39], v[32:35], v[40:43], v[36:39]
v_and_b32 v32, v30, v8
v_and_b32 v33, v30, v9
v_and_b32 v34, v30, v10
v_and_b32 v35, v30, v11
s_waitcnt vmcnt(9)
s_nop 0
v_mfma_f32_16x16x32_bf16 v[36:39], v[32:35], v[44:47], v[36:39]
v_and_b32 v32, v31, v8
v_and_b32 v33, v31, v9
v_and_b32 v34, v31, v10
v_and_b32 v35, v31, v11
ds_read_b128 v[28:31], v24 offset:128
s_waitcnt vmcnt(8)
v_mfma_f32_16x16x32_bf16 v[36:39], v[32:35], v[48:51], v[36:39]
s_waitcnt lgkmcnt(0)
v_and_b32 v32, v28, v8
v_and_b32 v33, v28, v9
v_and_b32 v34, v28, v10
v_and_b32 v35, v28, v11
s_waitcnt vmcnt(7)
s_nop 0
v_mfma_f32_16x16x32_bf16 v[36:39], v[32:35], v[56:59], v[36:39]
v_and_b32 v32, v29, v8
v_and_b32 v33, v29, v9
v_and_b32 v34, v29, v10
v_and_b32 v35, v29, v11
s_waitcnt vmcnt(6)
s_nop 0
v_mfma_f32_16x16x32_bf16 v[36:39], v[32:35], v[60:63], v[36:39]
v_and_b32 v32, v30, v8
v_and_b32 v33, v30, v9
v_and_b32 v34, v30, v10
v_and_b32 v35, v30, v11
s_waitcnt vmcnt(5)
s_nop 0
v_mfma_f32_16x16x32_bf16 v[36:39], v[32:35], v[64:67], v[36:39]
v_and_b32 v32, v31, v8
v_and_b32 v33, v31, v9
v_and_b32 v34, v31, v10
v_and_b32 v35, v31, v11
ds_read_b128 v[28:31], v24 offset:192
s_waitcnt vmcnt(4)
v_mfma_f32_16x16x32_bf16 v[36:39], v[32:35], v[68:71], v[36:39]
s_waitcnt lgkmcnt(0)
v_and_b32 v32, v28, v8
v_and_b32 v33, v28, v9
v_and_b32 v34, v28, v10
v_and_b32 v35, v28, v11
s_waitcnt vmcnt(3)
s_nop 0
v_mfma_f32_16x16x32_bf16 v[36:39], v[32:35], v[144:147], v[36:39]
v_and_b32 v32, v29, v8
v_and_b32 v33, v29, v9
v_and_b32 v34, v29, v10
v_and_b32 v35, v29, v11
s_waitcnt vmcnt(2)
s_nop 0
v_mfma_f32_16x16x32_bf16 v[36:39], v[32:35], v[148:151], v[36:39]
v_and_b32 v32, v30, v8
v_and_b32 v33, v30, v9
v_and_b32 v34, v30, v10
v_and_b32 v35, v30, v11
s_waitcnt vmcnt(1)
s_nop 0
v_mfma_f32_16x16x32_bf16 v[36:39], v[32:35], v[152:155], v[36:39]
v_and_b32 v32, v31, v8
v_and_b32 v33, v31, v9
v_and_b32 v34, v31, v10
v_and_b32 v35, v31, v11
s_waitcnt vmcnt(0)
s_nop 0
v_mfma_f32_16x16x32_bf16 v[36:39], v[32:35], v[156:159], v[36:39]
s_nop 7
ds_write_b128 v26, v[36:39]
v_lshl_add_u32 v3, v1, 2, s10
v_lshl_add_u32 v6, v5, 4, s10
s_lshl_b32 s6, s2, 11
s_lshl_b32 s7, s3, 8
s_add_u32 s6, s6, s7
s_add_u32 s14, s42, s6
s_addc_u32 s15, s43, 0
v_lshlrev_b32 v7, 2, v1
s_waitcnt lgkmcnt(0)
s_barrier
ds_read_b64 v[40:41], v0 offset:0
ds_read_b64 v[42:43], v0 offset:512
ds_read_b64 v[44:45], v0 offset:1024
ds_read_b64 v[46:47], v0 offset:1536
ds_read_b64 v[48:49], v0 offset:2048
ds_read_b64 v[50:51], v0 offset:2560
ds_read_b64 v[52:53], v0 offset:3072
ds_read_b64 v[54:55], v0 offset:3584
s_cmp_lg_u32 s3, 0
s_cbranch_scc1 L_noticket
s_lshl_b32 s6, s5, 4
v_mov_b32 v28, s6
v_mov_b32 v29, 1
s_mov_b64 exec, 1
global_atomic_add v29, v28, v29, s[40:41] sc0
s_mov_b64 exec, -1
L_noticket:
s_waitcnt lgkmcnt(0)
v_add_f32 v40, v40, v42
v_add_f32 v44, v44, v46
v_add_f32 v48, v48, v50
v_add_f32 v52, v52, v54
v_add_f32 v40, v40, v44
v_add_f32 v48, v48, v52
v_add_f32 v16, v40, v48
v_add_f32 v41, v41, v43
v_add_f32 v45, v45, v47
v_add_f32 v49, v49, v51
v_add_f32 v53, v53, v55
v_add_f32 v41, v41, v45
v_add_f32 v49, v49, v53
v_add_f32 v17, v41, v49
v_cvt_pk_bf16_f32 v16, v16, v17
ds_write_b32 v3, v16
s_waitcnt lgkmcnt(0)
ds_read_b128 v[40:43], v6 offset:0
ds_read_b128 v[44:47], v6 offset:64
ds_read_b128 v[48:51], v6 offset:128
ds_read_b128 v[52:55], v6 offset:192
s_waitcnt lgkmcnt(3)
v_mfma_f32_16x16x32_bf16 v[16:19], v[40:43], v[72:75], 0
v_mfma_f32_16x16x32_bf16 v[20:23], v[40:43], v[76:79], 0
v_mfma_f32_16x16x32_bf16 v[32:35], v[40:43], v[80:83], 0
v_mfma_f32_16x16x32_bf16 v[36:39], v[40:43], v[84:87], 0
s_waitcnt lgkmcnt(2)
v_mfma_f32_16x16x32_bf16 v[16:19], v[44:47], v[88:91], v[16:19]
v_mfma_f32_16x16x32_bf16 v[20:23], v[44:47], v[92:95], v[20:23]
v_mfma_f32_16x16x32_bf16 v[32:35], v[44:47], v[96:99], v[32:35]
v_mfma_f32_16x16x32_bf16 v[36:39], v[44:47], v[100:103], v[36:39]
s_waitcnt lgkmcnt(1)
v_mfma_f32_16x16x32_bf16 v[16:19], v[48:51], v[104:107], v[16:19]
v_mfma_f32_16x16x32_bf16 v[20:23], v[48:51], v[108:111], v[20:23]
v_mfma_f32_16x16x32_bf16 v[32:35], v[48:51], v[112:115], v[32:35]
v_mfma_f32_16x16x32_bf16 v[36:39], v[48:51], v[116:119], v[36:39]
s_waitcnt lgkmcnt(0)
v_mfma_f32_16x16x32_bf16 v[16:19], v[52:55], v[120:123], v[16:19]
v_mfma_f32_16x16x32_bf16 v[20:23], v[52:55], v[124:127], v[20:23]
v_mfma_f32_16x16x32_bf16 v[32:35], v[52:55], v[128:131], v[32:35]
v_mfma_f32_16x16x32_bf16 v[36:39], v[52:55], v[132:135], v[36:39]
s_nop 5
v_mov_b32_dpp v16, v20 quad_perm:[0,1,2,3] row_mask:0x2 bank_mask:0xf
v_mov_b32_dpp v16, v32 quad_perm:[0,1,2,3] row_mask:0x4 bank_mask:0xf
v_mov_b32_dpp v16, v36 quad_perm:[0,1,2,3] row_mask:0x8 bank_mask:0xf
v_mov_b32 v30, 0x7fc00000
v_cmp_eq_u32 vcc, -1, v16
s_nop 1
v_cndmask_b32 v16, v16, v30, vcc
s_cmp_lg_u32 s3, 0
s_cbranch_scc1 L_notick2
v_mov_b32 v28, 155712
s_waitcnt vmcnt(0)
s_mov_b64 exec, 1
ds_write_b32 v28, v29
s_mov_b64 exec, -1
L_notick2:
global_store_dword v7, v16, s[14:15] sc1
s_mov_b64 exec, -1
s_lshl_b32 s6, s5, 16
s_add_u32 s44, s42, s6
s_addc_u32 s45, s43, 0
s_mov_b32 s46, 0x10000
v_lshlrev_b32 v3, 14, v5
v_lshl_add_u32 v3, v4, 4, v3
s_lshl_b32 s7, s3, 8
v_add_u32 v3, s7, v3
s_lshl_b32 s6, s5, 11
s_add_u32 s6, s6, s7
s_add_u32 s6, s6, 524288
s_add_u32 s14, s42, s6
s_addc_u32 s15, s43, 0
s_lshl_b32 s6, s2, 2
s_add_u32 s6, s6, 540672
s_add_u32 s12, s42, s6
s_addc_u32 s13, s43, 0
s_lshl_b32 s6, s5, 10
s_lshl_b32 s7, s3, 7
s_add_u32 s6, s6, s7
s_add_u32 s70, s38, s6
s_addc_u32 s71, s39, 0
v_lshlrev_b32 v27, 4, v4
v_mov_b32 v7, 0
s_movk_i32 s8, 0x1000
s_movk_i32 s9, 0x2000
s_movk_i32 s10, 0x3000
s_waitcnt lgkmcnt(0)
s_barrier
v_mov_b32 v28, 155712
ds_read_b32 v6, v28
s_waitcnt lgkmcnt(0)
v_readfirstlane_b32 s6, v6
s_nop 3
s_cmp_lg_u32 s6, 31
s_cbranch_scc1 L_fin
global_load_dwordx4 v[72:75], v27, s[14:15] sc1
global_load_dword v76, v7, s[12:13] sc1
L_poll:
buffer_load_dwordx4 v[40:43], v3, s[44:47], 0 offen offset:0 sc1
buffer_load_dwordx4 v[44:47], v3, s[44:47], 0 offen offset:2048 sc1
buffer_load_dwordx4 v[48:51], v3, s[44:47], s8 offen offset:0 sc1
buffer_load_dwordx4 v[52:55], v3, s[44:47], s8 offen offset:2048 sc1
buffer_load_dwordx4 v[56:59], v3, s[44:47], s9 offen offset:0 sc1
buffer_load_dwordx4 v[60:63], v3, s[44:47], s9 offen offset:2048 sc1
buffer_load_dwordx4 v[64:67], v3, s[44:47], s10 offen offset:0 sc1
buffer_load_dwordx4 v[68:71], v3, s[44:47], s10 offen offset:2048 sc1
s_waitcnt vmcnt(0)
v_max3_u32 v16, v40, v41, v42
v_max3_u32 v16, v16, v43, v44
v_max3_u32 v16, v16, v45, v46
v_max3_u32 v16, v16, v47, v48
v_max3_u32 v16, v16, v49, v50
v_max3_u32 v16, v16, v51, v52
v_max3_u32 v16, v16, v53, v54
v_max3_u32 v16, v16, v55, v56
v_max3_u32 v16, v16, v57, v58
v_max3_u32 v16, v16, v59, v60
v_max3_u32 v16, v16, v61, v62
v_max3_u32 v16, v16, v63, v64
v_max3_u32 v16, v16, v65, v66
v_max3_u32 v16, v16, v67, v68
v_max3_u32 v16, v16, v69, v70
v_max_u32 v16, v16, v71
v_cmp_eq_u32 vcc, -1, v16
s_nop 4
s_cbranch_vccnz L_poll
v_lshlrev_b32 v6, 3, v4
v_add_f32 v40, v40, v44
v_add_f32 v48, v48, v52
v_add_f32 v56, v56, v60
v_add_f32 v64, v64, v68
v_add_f32 v40, v40, v48
v_add_f32 v56, v56, v64
v_add_f32 v16, v40, v56
v_add_f32 v41, v41, v45
v_add_f32 v49, v49, v53
v_add_f32 v57, v57, v61
v_add_f32 v65, v65, v69
v_add_f32 v41, v41, v49
v_add_f32 v57, v57, v65
v_add_f32 v17, v41, v57
v_add_f32 v42, v42, v46
v_add_f32 v50, v50, v54
v_add_f32 v58, v58, v62
v_add_f32 v66, v66, v70
v_add_f32 v42, v42, v50
v_add_f32 v58, v58, v66
v_add_f32 v18, v42, v58
v_add_f32 v43, v43, v47
v_add_f32 v51, v51, v55
v_add_f32 v59, v59, v63
v_add_f32 v67, v67, v71
v_add_f32 v43, v43, v51
v_add_f32 v59, v59, v67
v_add_f32 v19, v43, v59
v_mov_b32 v20, v16
v_mov_b32 v21, v17
v_mov_b32 v22, v18
v_mov_b32 v23, v19
v_permlane16_swap_b32 v16, v20
v_permlane16_swap_b32 v17, v21
v_permlane16_swap_b32 v18, v22
v_permlane16_swap_b32 v19, v23
v_add_f32 v16, v16, v20
v_add_f32 v17, v17, v21
v_add_f32 v18, v18, v22
v_add_f32 v19, v19, v23
v_mov_b32 v20, v16
v_mov_b32 v21, v17
v_mov_b32 v22, v18
v_mov_b32 v23, v19
v_permlane32_swap_b32 v16, v20
v_permlane32_swap_b32 v17, v21
v_permlane32_swap_b32 v18, v22
v_permlane32_swap_b32 v19, v23
v_add_f32 v16, v16, v20
v_add_f32 v17, v17, v21
v_add_f32 v18, v18, v22
v_add_f32 v19, v19, v23
v_cvt_pk_bf16_f32 v20, v16, v17
v_lshlrev_b32 v16, 16, v20
v_and_b32 v17, s66, v20
v_cvt_pk_bf16_f32 v21, v18, v19
v_lshlrev_b32 v18, 16, v21
v_and_b32 v19, s66, v21
s_waitcnt vmcnt(0)
v_mul_f32 v16, v76, v16
v_mul_f32 v17, v76, v17
v_mul_f32 v18, v76, v18
v_mul_f32 v19, v76, v19
v_cvt_pk_bf16_f32 v20, v16, v17
v_lshlrev_b32 v16, 16, v20
v_and_b32 v17, s66, v20
v_cvt_pk_bf16_f32 v21, v18, v19
v_lshlrev_b32 v18, 16, v21
v_and_b32 v19, s66, v21
v_add_f32 v16, v16, v72
v_add_f32 v17, v17, v73
v_add_f32 v18, v18, v74
v_add_f32 v19, v19, v75
v_cvt_pk_bf16_f32 v20, v16, v17
v_cvt_pk_bf16_f32 v21, v18, v19
s_mov_b64 exec, 0xffff
global_store_dwordx2 v6, v[20:21], s[70:71] sc1
L_fin:
s_endpgm
L_helper:
s_mov_b32 s46, 3584
s_mov_b32 s47, 0x20000
s_mov_b32 s50, 3584
s_mov_b32 s51, 0x20000
s_mov_b32 s54, 3584
s_mov_b32 s55, 0x20000
s_lshl_b32 s6, s5, 10
s_waitcnt lgkmcnt(0)
s_add_u32 s16, s16, s6
s_addc_u32 s17, s17, 0
s_mov_b32 s44, s28
s_mov_b32 s45, s29
s_mov_b32 s48, s30
s_mov_b32 s49, s31
s_mov_b32 s52, s32
s_mov_b32 s53, s33
v_mov_b32 v7, 0
global_load_dwordx4 v[12:15], v2, s[16:17]
global_load_dwordx4 v[16:19], v2, s[36:37]
global_load_ushort v20, v7, s[34:35]
buffer_load_dwordx4 v[120:123], v2, s[44:47], 0 offen offset:0
buffer_load_dwordx4 v[124:127], v2, s[44:47], 0 offen offset:1024
buffer_load_dwordx4 v[128:131], v2, s[44:47], 0 offen offset:2048
buffer_load_dwordx4 v[132:135], v2, s[44:47], 0 offen offset:3072
buffer_load_dwordx4 v[136:139], v2, s[48:51], 0 offen offset:0
buffer_load_dwordx4 v[140:143], v2, s[48:51], 0 offen offset:1024
buffer_load_dwordx4 v[144:147], v2, s[48:51], 0 offen offset:2048
buffer_load_dwordx4 v[148:151], v2, s[48:51], 0 offen offset:3072
buffer_load_dwordx4 v[104:107], v2, s[52:55], 0 offen offset:0
buffer_load_dwordx4 v[108:111], v2, s[52:55], 0 offen offset:1024
buffer_load_dwordx4 v[112:115], v2, s[52:55], 0 offen offset:2048
buffer_load_dwordx4 v[116:119], v2, s[52:55], 0 offen offset:3072
s_barrier
s_waitcnt vmcnt(12)
v_lshlrev_b32 v40, 16, v12
v_and_b32 v41, s66, v12
v_lshlrev_b32 v48, 16, v16
v_and_b32 v49, s66, v16
v_lshlrev_b32 v42, 16, v13
v_and_b32 v43, s66, v13
v_lshlrev_b32 v50, 16, v17
v_and_b32 v51, s66, v17
v_lshlrev_b32 v44, 16, v14
v_and_b32 v45, s66, v14
v_lshlrev_b32 v52, 16, v18
v_and_b32 v53, s66, v18
v_lshlrev_b32 v46, 16, v15
v_and_b32 v47, s66, v15
v_lshlrev_b32 v54, 16, v19
v_and_b32 v55, s66, v19
v_mul_f32 v40, v40, v48
v_mul_f32 v41, v41, v49
v_mul_f32 v42, v42, v50
v_mul_f32 v43, v43, v51
v_mul_f32 v44, v44, v52
v_mul_f32 v45, v45, v53
v_mul_f32 v46, v46, v54
v_mul_f32 v47, v47, v55
v_cvt_pk_bf16_f32 v3, v40, v41
v_lshlrev_b32 v40, 16, v3
v_and_b32 v41, s66, v3
v_cvt_pk_bf16_f32 v3, v42, v43
v_lshlrev_b32 v42, 16, v3
v_and_b32 v43, s66, v3
v_cvt_pk_bf16_f32 v3, v44, v45
v_lshlrev_b32 v44, 16, v3
v_and_b32 v45, s66, v3
v_cvt_pk_bf16_f32 v3, v46, v47
v_lshlrev_b32 v46, 16, v3
v_and_b32 v47, s66, v3
v_add_f32 v40, v40, v41
v_add_f32 v40, v40, v42
v_add_f32 v40, v40, v43
v_add_f32 v40, v40, v44
v_add_f32 v40, v40, v45
v_add_f32 v40, v40, v46
v_add_f32 v40, v40, v47
s_nop 1
v_add_f32_dpp v40, v40, v40 row_ror:8 row_mask:0xf bank_mask:0xf
s_nop 1
v_add_f32_dpp v40, v40, v40 row_ror:4 row_mask:0xf bank_mask:0xf
s_nop 1
v_add_f32_dpp v40, v40, v40 row_ror:2 row_mask:0xf bank_mask:0xf
s_nop 1
v_add_f32_dpp v40, v40, v40 row_ror:1 row_mask:0xf bank_mask:0xf
v_mov_b32 v3, v40
s_nop 1
v_permlane16_swap_b32 v40, v3
v_add_f32 v40, v40, v3
v_mov_b32 v3, v40
s_nop 1
v_permlane32_swap_b32 v40, v3
v_add_f32 v40, v40, v3
v_cvt_pk_bf16_f32 v3, v40, v40
v_lshlrev_b32 v40, 16, v3
v_mul_f32 v21, s65, v40
v_exp_f32 v21, -v21
s_nop 0
v_add_f32 v21, 1.0, v21
v_rcp_f32 v21, v21
s_nop 0
v_cvt_pk_bf16_f32 v3, v21, v21
v_lshlrev_b32 v21, 16, v3
v_sub_f32 v22, 1.0, v21
v_cvt_pk_bf16_f32 v3, v22, v22
v_lshlrev_b32 v22, 16, v3
v_lshlrev_b32 v40, 16, v12
v_and_b32 v41, s66, v12
v_lshlrev_b32 v42, 16, v13
v_and_b32 v43, s66, v13
v_lshlrev_b32 v44, 16, v14
v_and_b32 v45, s66, v14
v_lshlrev_b32 v46, 16, v15
v_and_b32 v47, s66, v15
v_add_f32 v23, v40, v41
v_add_f32 v23, v23, v42
v_add_f32 v23, v23, v43
v_add_f32 v23, v23, v44
v_add_f32 v23, v23, v45
v_add_f32 v23, v23, v46
v_add_f32 v23, v23, v47
s_nop 1
v_add_f32_dpp v23, v23, v23 row_ror:8 row_mask:0xf bank_mask:0xf
s_nop 1
v_add_f32_dpp v23, v23, v23 row_ror:4 row_mask:0xf bank_mask:0xf
s_nop 1
v_add_f32_dpp v23, v23, v23 row_ror:2 row_mask:0xf bank_mask:0xf
s_nop 1
v_add_f32_dpp v23, v23, v23 row_ror:1 row_mask:0xf bank_mask:0xf
v_mov_b32 v3, v23
s_nop 1
v_permlane16_swap_b32 v23, v3
v_add_f32 v23, v23, v3
v_mov_b32 v3, v23
s_nop 1
v_permlane32_swap_b32 v23, v3
v_add_f32 v23, v23, v3
s_mov_b32 s6, 0x3b000000
v_mul_f32 v23, s6, v23
v_sub_f32 v48, v40, v23
v_sub_f32 v49, v41, v23
v_sub_f32 v50, v42, v23
v_sub_f32 v51, v43, v23
v_sub_f32 v52, v44, v23
v_sub_f32 v53, v45, v23
v_sub_f32 v54, v46, v23
v_sub_f32 v55, v47, v23
v_mul_f32 v24, v48, v48
v_fmac_f32 v24, v49, v49
v_fmac_f32 v24, v50, v50
v_fmac_f32 v24, v51, v51
v_fmac_f32 v24, v52, v52
v_fmac_f32 v24, v53, v53
v_fmac_f32 v24, v54, v54
v_fmac_f32 v24, v55, v55
s_nop 1
v_add_f32_dpp v24, v24, v24 row_ror:8 row_mask:0xf bank_mask:0xf
s_nop 1
v_add_f32_dpp v24, v24, v24 row_ror:4 row_mask:0xf bank_mask:0xf
s_nop 1
v_add_f32_dpp v24, v24, v24 row_ror:2 row_mask:0xf bank_mask:0xf
s_nop 1
v_add_f32_dpp v24, v24, v24 row_ror:1 row_mask:0xf bank_mask:0xf
v_mov_b32 v3, v24
s_nop 1
v_permlane16_swap_b32 v24, v3
v_add_f32 v24, v24, v3
v_mov_b32 v3, v24
s_nop 1
v_permlane32_swap_b32 v24, v3
v_add_f32 v24, v24, v3
v_mul_f32 v24, s6, v24
v_cvt_pk_bf16_f32 v3, v24, v24
v_lshlrev_b32 v24, 16, v3
v_cvt_pk_bf16_f32 v3, v23, v23
v_lshlrev_b32 v23, 16, v3
v_add_f32 v24, 0x3727c5ac, v24
v_cvt_pk_bf16_f32 v3, v24, v24
v_lshlrev_b32 v24, 16, v3
v_sqrt_f32 v24, v24
s_nop 0
v_cvt_pk_bf16_f32 v3, v24, v24
v_lshlrev_b32 v24, 16, v3
v_rcp_f32 v24, v24
v_sub_f32 v40, v40, v23
v_sub_f32 v41, v41, v23
v_sub_f32 v42, v42, v23
v_sub_f32 v43, v43, v23
v_sub_f32 v44, v44, v23
v_sub_f32 v45, v45, v23
v_sub_f32 v46, v46, v23
v_sub_f32 v47, v47, v23
v_cvt_pk_bf16_f32 v3, v40, v41
v_lshlrev_b32 v40, 16, v3
v_and_b32 v41, s66, v3
v_cvt_pk_bf16_f32 v3, v42, v43
v_lshlrev_b32 v42, 16, v3
v_and_b32 v43, s66, v3
v_cvt_pk_bf16_f32 v3, v44, v45
v_lshlrev_b32 v44, 16, v3
v_and_b32 v45, s66, v3
v_cvt_pk_bf16_f32 v3, v46, v47
v_lshlrev_b32 v46, 16, v3
v_and_b32 v47, s66, v3
v_mul_f32 v40, v40, v24
v_mul_f32 v41, v41, v24
v_mul_f32 v42, v42, v24
v_mul_f32 v43, v43, v24
v_mul_f32 v44, v44, v24
v_mul_f32 v45, v45, v24
v_mul_f32 v46, v46, v24
v_mul_f32 v47, v47, v24
v_cvt_pk_bf16_f32 v3, v40, v41
v_lshlrev_b32 v40, 16, v3
v_and_b32 v41, s66, v3
v_cvt_pk_bf16_f32 v3, v42, v43
v_lshlrev_b32 v42, 16, v3
v_and_b32 v43, s66, v3
v_cvt_pk_bf16_f32 v3, v44, v45
v_lshlrev_b32 v44, 16, v3
v_and_b32 v45, s66, v3
v_cvt_pk_bf16_f32 v3, v46, v47
v_lshlrev_b32 v46, 16, v3
v_and_b32 v47, s66, v3
s_lshl_b32 s6, s4, 1
s_add_u32 s7, s6, 1
v_readlane_b32 s80, v40, s6
v_readlane_b32 s81, v41, s6
v_readlane_b32 s82, v42, s6
v_readlane_b32 s83, v43, s6
v_readlane_b32 s84, v44, s6
v_readlane_b32 s85, v45, s6
v_readlane_b32 s86, v46, s6
v_readlane_b32 s87, v47, s6
v_readlane_b32 s88, v40, s7
v_readlane_b32 s89, v41, s7
v_readlane_b32 s90, v42, s7
v_readlane_b32 s91, v43, s7
v_readlane_b32 s92, v44, s7
v_readlane_b32 s93, v45, s7
v_readlane_b32 s94, v46, s7
v_readlane_b32 s95, v47, s7
v_lshlrev_b32 v20, 16, v20
s_waitcnt vmcnt(0)
v_lshlrev_b32 v40, 16, v120
v_and_b32 v41, s66, v120
v_lshlrev_b32 v72, 16, v136
v_and_b32 v73, s66, v136
v_lshlrev_b32 v42, 16, v121
v_and_b32 v43, s66, v121
v_lshlrev_b32 v74, 16, v137
v_and_b32 v75, s66, v137
v_lshlrev_b32 v44, 16, v122
v_and_b32 v45, s66, v122
v_lshlrev_b32 v76, 16, v138
v_and_b32 v77, s66, v138
v_lshlrev_b32 v46, 16, v123
v_and_b32 v47, s66, v123
v_lshlrev_b32 v78, 16, v139
v_and_b32 v79, s66, v139
v_lshlrev_b32 v48, 16, v124
v_and_b32 v49, s66, v124
v_lshlrev_b32 v80, 16, v140
v_and_b32 v81, s66, v140
v_lshlrev_b32 v50, 16, v125
v_and_b32 v51, s66, v125
v_lshlrev_b32 v82, 16, v141
v_and_b32 v83, s66, v141
v_lshlrev_b32 v52, 16, v126
v_and_b32 v53, s66, v126
v_lshlrev_b32 v84, 16, v142
v_and_b32 v85, s66, v142
v_lshlrev_b32 v54, 16, v127
v_and_b32 v55, s66, v127
v_lshlrev_b32 v86, 16, v143
v_and_b32 v87, s66, v143
v_lshlrev_b32 v56, 16, v128
v_and_b32 v57, s66, v128
v_lshlrev_b32 v88, 16, v144
v_and_b32 v89, s66, v144
v_lshlrev_b32 v58, 16, v129
v_and_b32 v59, s66, v129
v_lshlrev_b32 v90, 16, v145
v_and_b32 v91, s66, v145
v_lshlrev_b32 v60, 16, v130
v_and_b32 v61, s66, v130
v_lshlrev_b32 v92, 16, v146
v_and_b32 v93, s66, v146
v_lshlrev_b32 v62, 16, v131
v_and_b32 v63, s66, v131
v_lshlrev_b32 v94, 16, v147
v_and_b32 v95, s66, v147
v_lshlrev_b32 v64, 16, v132
v_and_b32 v65, s66, v132
v_lshlrev_b32 v96, 16, v148
v_and_b32 v97, s66, v148
v_lshlrev_b32 v66, 16, v133
v_and_b32 v67, s66, v133
v_lshlrev_b32 v98, 16, v149
v_and_b32 v99, s66, v149
v_lshlrev_b32 v68, 16, v134
v_and_b32 v69, s66, v134
v_lshlrev_b32 v100, 16, v150
v_and_b32 v101, s66, v150
v_lshlrev_b32 v70, 16, v135
v_and_b32 v71, s66, v135
v_lshlrev_b32 v102, 16, v151
v_and_b32 v103, s66, v151
v_mov_b32 v8, 0xbdd2d3e8
v_mov_b32 v9, v8
v_mov_b32 v10, 0xc0135761
v_mov_b32 v11, v10
v_mov_b32 v12, 1.0
v_mov_b32 v13, 1.0
v_mov_b32 v25, 0
s_mov_b32 s61, 0
L_hloop:
s_mov_b32 m0, s61
s_nop 0
s_movrels_b32 s6, s80
v_mov_b32 v14, s6
v_mov_b32 v15, s6
v_mov_b32 v26, 0
v_pk_mul_f32 v[16:17], v[40:41], v[14:15]
v_cvt_pk_bf16_f32 v24, v16, v17
v_lshlrev_b32 v16, 16, v24
v_and_b32 v17, s66, v24
v_pk_add_f32 v[16:17], v[16:17], v[72:73]
v_cvt_pk_bf16_f32 v24, v16, v17
v_lshlrev_b32 v16, 16, v24
v_and_b32 v17, s66, v24
v_pk_mul_f32 v[18:19], v[16:17], v[16:17]
v_pk_fma_f32 v[18:19], v[18:19], v[8:9], v[10:11]
v_pk_mul_f32 v[18:19], v[18:19], v[16:17]
v_exp_f32 v18, v18
v_exp_f32 v19, v19
s_nop 0
v_pk_add_f32 v[18:19], v[18:19], v[12:13]
v_rcp_f32 v18, v18
v_rcp_f32 v19, v19
s_nop 0
v_pk_mul_f32 v[18:19], v[18:19], v[16:17]
v_cvt_pk_bf16_f32 v24, v18, v19
v_dot2c_f32_bf16 v26, v24, v104
v_pk_mul_f32 v[28:29], v[42:43], v[14:15]
v_cvt_pk_bf16_f32 v27, v28, v29
v_lshlrev_b32 v28, 16, v27
v_and_b32 v29, s66, v27
v_pk_add_f32 v[28:29], v[28:29], v[74:75]
v_cvt_pk_bf16_f32 v27, v28, v29
v_lshlrev_b32 v28, 16, v27
v_and_b32 v29, s66, v27
v_pk_mul_f32 v[30:31], v[28:29], v[28:29]
v_pk_fma_f32 v[30:31], v[30:31], v[8:9], v[10:11]
v_pk_mul_f32 v[30:31], v[30:31], v[28:29]
v_exp_f32 v30, v30
v_exp_f32 v31, v31
s_nop 0
v_pk_add_f32 v[30:31], v[30:31], v[12:13]
v_rcp_f32 v30, v30
v_rcp_f32 v31, v31
s_nop 0
v_pk_mul_f32 v[30:31], v[30:31], v[28:29]
v_cvt_pk_bf16_f32 v27, v30, v31
v_dot2c_f32_bf16 v26, v27, v105
v_pk_mul_f32 v[16:17], v[44:45], v[14:15]
v_cvt_pk_bf16_f32 v24, v16, v17
v_lshlrev_b32 v16, 16, v24
v_and_b32 v17, s66, v24
v_pk_add_f32 v[16:17], v[16:17], v[76:77]
v_cvt_pk_bf16_f32 v24, v16, v17
v_lshlrev_b32 v16, 16, v24
v_and_b32 v17, s66, v24
v_pk_mul_f32 v[18:19], v[16:17], v[16:17]
v_pk_fma_f32 v[18:19], v[18:19], v[8:9], v[10:11]
v_pk_mul_f32 v[18:19], v[18:19], v[16:17]
v_exp_f32 v18, v18
v_exp_f32 v19, v19
s_nop 0
v_pk_add_f32 v[18:19], v[18:19], v[12:13]
v_rcp_f32 v18, v18
v_rcp_f32 v19, v19
s_nop 0
v_pk_mul_f32 v[18:19], v[18:19], v[16:17]
v_cvt_pk_bf16_f32 v24, v18, v19
v_dot2c_f32_bf16 v26, v24, v106
v_pk_mul_f32 v[28:29], v[46:47], v[14:15]
v_cvt_pk_bf16_f32 v27, v28, v29
v_lshlrev_b32 v28, 16, v27
v_and_b32 v29, s66, v27
v_pk_add_f32 v[28:29], v[28:29], v[78:79]
v_cvt_pk_bf16_f32 v27, v28, v29
v_lshlrev_b32 v28, 16, v27
v_and_b32 v29, s66, v27
v_pk_mul_f32 v[30:31], v[28:29], v[28:29]
v_pk_fma_f32 v[30:31], v[30:31], v[8:9], v[10:11]
v_pk_mul_f32 v[30:31], v[30:31], v[28:29]
v_exp_f32 v30, v30
v_exp_f32 v31, v31
s_nop 0
v_pk_add_f32 v[30:31], v[30:31], v[12:13]
v_rcp_f32 v30, v30
v_rcp_f32 v31, v31
s_nop 0
v_pk_mul_f32 v[30:31], v[30:31], v[28:29]
v_cvt_pk_bf16_f32 v27, v30, v31
v_dot2c_f32_bf16 v26, v27, v107
v_pk_mul_f32 v[16:17], v[48:49], v[14:15]
v_cvt_pk_bf16_f32 v24, v16, v17
v_lshlrev_b32 v16, 16, v24
v_and_b32 v17, s66, v24
v_pk_add_f32 v[16:17], v[16:17], v[80:81]
v_cvt_pk_bf16_f32 v24, v16, v17
v_lshlrev_b32 v16, 16, v24
v_and_b32 v17, s66, v24
v_pk_mul_f32 v[18:19], v[16:17], v[16:17]
v_pk_fma_f32 v[18:19], v[18:19], v[8:9], v[10:11]
v_pk_mul_f32 v[18:19], v[18:19], v[16:17]
v_exp_f32 v18, v18
v_exp_f32 v19, v19
s_nop 0
v_pk_add_f32 v[18:19], v[18:19], v[12:13]
v_rcp_f32 v18, v18
v_rcp_f32 v19, v19
s_nop 0
v_pk_mul_f32 v[18:19], v[18:19], v[16:17]
v_cvt_pk_bf16_f32 v24, v18, v19
v_dot2c_f32_bf16 v26, v24, v108
v_pk_mul_f32 v[28:29], v[50:51], v[14:15]
v_cvt_pk_bf16_f32 v27, v28, v29
v_lshlrev_b32 v28, 16, v27
v_and_b32 v29, s66, v27
v_pk_add_f32 v[28:29], v[28:29], v[82:83]
v_cvt_pk_bf16_f32 v27, v28, v29
v_lshlrev_b32 v28, 16, v27
v_and_b32 v29, s66, v27
v_pk_mul_f32 v[30:31], v[28:29], v[28:29]
v_pk_fma_f32 v[30:31], v[30:31], v[8:9], v[10:11]
v_pk_mul_f32 v[30:31], v[30:31], v[28:29]
v_exp_f32 v30, v30
v_exp_f32 v31, v31
s_nop 0
v_pk_add_f32 v[30:31], v[30:31], v[12:13]
v_rcp_f32 v30, v30
v_rcp_f32 v31, v31
s_nop 0
v_pk_mul_f32 v[30:31], v[30:31], v[28:29]
v_cvt_pk_bf16_f32 v27, v30, v31
v_dot2c_f32_bf16 v26, v27, v109
v_pk_mul_f32 v[16:17], v[52:53], v[14:15]
v_cvt_pk_bf16_f32 v24, v16, v17
v_lshlrev_b32 v16, 16, v24
v_and_b32 v17, s66, v24
v_pk_add_f32 v[16:17], v[16:17], v[84:85]
v_cvt_pk_bf16_f32 v24, v16, v17
v_lshlrev_b32 v16, 16, v24
v_and_b32 v17, s66, v24
v_pk_mul_f32 v[18:19], v[16:17], v[16:17]
v_pk_fma_f32 v[18:19], v[18:19], v[8:9], v[10:11]
v_pk_mul_f32 v[18:19], v[18:19], v[16:17]
v_exp_f32 v18, v18
v_exp_f32 v19, v19
s_nop 0
v_pk_add_f32 v[18:19], v[18:19], v[12:13]
v_rcp_f32 v18, v18
v_rcp_f32 v19, v19
s_nop 0
v_pk_mul_f32 v[18:19], v[18:19], v[16:17]
v_cvt_pk_bf16_f32 v24, v18, v19
v_dot2c_f32_bf16 v26, v24, v110
v_pk_mul_f32 v[28:29], v[54:55], v[14:15]
v_cvt_pk_bf16_f32 v27, v28, v29
v_lshlrev_b32 v28, 16, v27
v_and_b32 v29, s66, v27
v_pk_add_f32 v[28:29], v[28:29], v[86:87]
v_cvt_pk_bf16_f32 v27, v28, v29
v_lshlrev_b32 v28, 16, v27
v_and_b32 v29, s66, v27
v_pk_mul_f32 v[30:31], v[28:29], v[28:29]
v_pk_fma_f32 v[30:31], v[30:31], v[8:9], v[10:11]
v_pk_mul_f32 v[30:31], v[30:31], v[28:29]
v_exp_f32 v30, v30
v_exp_f32 v31, v31
s_nop 0
v_pk_add_f32 v[30:31], v[30:31], v[12:13]
v_rcp_f32 v30, v30
v_rcp_f32 v31, v31
s_nop 0
v_pk_mul_f32 v[30:31], v[30:31], v[28:29]
v_cvt_pk_bf16_f32 v27, v30, v31
v_dot2c_f32_bf16 v26, v27, v111
v_pk_mul_f32 v[16:17], v[56:57], v[14:15]
v_cvt_pk_bf16_f32 v24, v16, v17
v_lshlrev_b32 v16, 16, v24
v_and_b32 v17, s66, v24
v_pk_add_f32 v[16:17], v[16:17], v[88:89]
v_cvt_pk_bf16_f32 v24, v16, v17
v_lshlrev_b32 v16, 16, v24
v_and_b32 v17, s66, v24
v_pk_mul_f32 v[18:19], v[16:17], v[16:17]
v_pk_fma_f32 v[18:19], v[18:19], v[8:9], v[10:11]
v_pk_mul_f32 v[18:19], v[18:19], v[16:17]
v_exp_f32 v18, v18
v_exp_f32 v19, v19
s_nop 0
v_pk_add_f32 v[18:19], v[18:19], v[12:13]
v_rcp_f32 v18, v18
v_rcp_f32 v19, v19
s_nop 0
v_pk_mul_f32 v[18:19], v[18:19], v[16:17]
v_cvt_pk_bf16_f32 v24, v18, v19
v_dot2c_f32_bf16 v26, v24, v112
v_pk_mul_f32 v[28:29], v[58:59], v[14:15]
v_cvt_pk_bf16_f32 v27, v28, v29
v_lshlrev_b32 v28, 16, v27
v_and_b32 v29, s66, v27
v_pk_add_f32 v[28:29], v[28:29], v[90:91]
v_cvt_pk_bf16_f32 v27, v28, v29
v_lshlrev_b32 v28, 16, v27
v_and_b32 v29, s66, v27
v_pk_mul_f32 v[30:31], v[28:29], v[28:29]
v_pk_fma_f32 v[30:31], v[30:31], v[8:9], v[10:11]
v_pk_mul_f32 v[30:31], v[30:31], v[28:29]
v_exp_f32 v30, v30
v_exp_f32 v31, v31
s_nop 0
v_pk_add_f32 v[30:31], v[30:31], v[12:13]
v_rcp_f32 v30, v30
v_rcp_f32 v31, v31
s_nop 0
v_pk_mul_f32 v[30:31], v[30:31], v[28:29]
v_cvt_pk_bf16_f32 v27, v30, v31
v_dot2c_f32_bf16 v26, v27, v113
v_pk_mul_f32 v[16:17], v[60:61], v[14:15]
v_cvt_pk_bf16_f32 v24, v16, v17
v_lshlrev_b32 v16, 16, v24
v_and_b32 v17, s66, v24
v_pk_add_f32 v[16:17], v[16:17], v[92:93]
v_cvt_pk_bf16_f32 v24, v16, v17
v_lshlrev_b32 v16, 16, v24
v_and_b32 v17, s66, v24
v_pk_mul_f32 v[18:19], v[16:17], v[16:17]
v_pk_fma_f32 v[18:19], v[18:19], v[8:9], v[10:11]
v_pk_mul_f32 v[18:19], v[18:19], v[16:17]
v_exp_f32 v18, v18
v_exp_f32 v19, v19
s_nop 0
v_pk_add_f32 v[18:19], v[18:19], v[12:13]
v_rcp_f32 v18, v18
v_rcp_f32 v19, v19
s_nop 0
v_pk_mul_f32 v[18:19], v[18:19], v[16:17]
v_cvt_pk_bf16_f32 v24, v18, v19
v_dot2c_f32_bf16 v26, v24, v114
v_pk_mul_f32 v[28:29], v[62:63], v[14:15]
v_cvt_pk_bf16_f32 v27, v28, v29
v_lshlrev_b32 v28, 16, v27
v_and_b32 v29, s66, v27
v_pk_add_f32 v[28:29], v[28:29], v[94:95]
v_cvt_pk_bf16_f32 v27, v28, v29
v_lshlrev_b32 v28, 16, v27
v_and_b32 v29, s66, v27
v_pk_mul_f32 v[30:31], v[28:29], v[28:29]
v_pk_fma_f32 v[30:31], v[30:31], v[8:9], v[10:11]
v_pk_mul_f32 v[30:31], v[30:31], v[28:29]
v_exp_f32 v30, v30
v_exp_f32 v31, v31
s_nop 0
v_pk_add_f32 v[30:31], v[30:31], v[12:13]
v_rcp_f32 v30, v30
v_rcp_f32 v31, v31
s_nop 0
v_pk_mul_f32 v[30:31], v[30:31], v[28:29]
v_cvt_pk_bf16_f32 v27, v30, v31
v_dot2c_f32_bf16 v26, v27, v115
v_pk_mul_f32 v[16:17], v[64:65], v[14:15]
v_cvt_pk_bf16_f32 v24, v16, v17
v_lshlrev_b32 v16, 16, v24
v_and_b32 v17, s66, v24
v_pk_add_f32 v[16:17], v[16:17], v[96:97]
v_cvt_pk_bf16_f32 v24, v16, v17
v_lshlrev_b32 v16, 16, v24
v_and_b32 v17, s66, v24
v_pk_mul_f32 v[18:19], v[16:17], v[16:17]
v_pk_fma_f32 v[18:19], v[18:19], v[8:9], v[10:11]
v_pk_mul_f32 v[18:19], v[18:19], v[16:17]
v_exp_f32 v18, v18
v_exp_f32 v19, v19
s_nop 0
v_pk_add_f32 v[18:19], v[18:19], v[12:13]
v_rcp_f32 v18, v18
v_rcp_f32 v19, v19
s_nop 0
v_pk_mul_f32 v[18:19], v[18:19], v[16:17]
v_cvt_pk_bf16_f32 v24, v18, v19
v_dot2c_f32_bf16 v26, v24, v116
v_pk_mul_f32 v[28:29], v[66:67], v[14:15]
v_cvt_pk_bf16_f32 v27, v28, v29
v_lshlrev_b32 v28, 16, v27
v_and_b32 v29, s66, v27
v_pk_add_f32 v[28:29], v[28:29], v[98:99]
v_cvt_pk_bf16_f32 v27, v28, v29
v_lshlrev_b32 v28, 16, v27
v_and_b32 v29, s66, v27
v_pk_mul_f32 v[30:31], v[28:29], v[28:29]
v_pk_fma_f32 v[30:31], v[30:31], v[8:9], v[10:11]
v_pk_mul_f32 v[30:31], v[30:31], v[28:29]
v_exp_f32 v30, v30
v_exp_f32 v31, v31
s_nop 0
v_pk_add_f32 v[30:31], v[30:31], v[12:13]
v_rcp_f32 v30, v30
v_rcp_f32 v31, v31
s_nop 0
v_pk_mul_f32 v[30:31], v[30:31], v[28:29]
v_cvt_pk_bf16_f32 v27, v30, v31
v_dot2c_f32_bf16 v26, v27, v117
v_pk_mul_f32 v[16:17], v[68:69], v[14:15]
v_cvt_pk_bf16_f32 v24, v16, v17
v_lshlrev_b32 v16, 16, v24
v_and_b32 v17, s66, v24
v_pk_add_f32 v[16:17], v[16:17], v[100:101]
v_cvt_pk_bf16_f32 v24, v16, v17
v_lshlrev_b32 v16, 16, v24
v_and_b32 v17, s66, v24
v_pk_mul_f32 v[18:19], v[16:17], v[16:17]
v_pk_fma_f32 v[18:19], v[18:19], v[8:9], v[10:11]
v_pk_mul_f32 v[18:19], v[18:19], v[16:17]
v_exp_f32 v18, v18
v_exp_f32 v19, v19
s_nop 0
v_pk_add_f32 v[18:19], v[18:19], v[12:13]
v_rcp_f32 v18, v18
v_rcp_f32 v19, v19
s_nop 0
v_pk_mul_f32 v[18:19], v[18:19], v[16:17]
v_cvt_pk_bf16_f32 v24, v18, v19
v_dot2c_f32_bf16 v26, v24, v118
v_pk_mul_f32 v[28:29], v[70:71], v[14:15]
v_cvt_pk_bf16_f32 v27, v28, v29
v_lshlrev_b32 v28, 16, v27
v_and_b32 v29, s66, v27
v_pk_add_f32 v[28:29], v[28:29], v[102:103]
v_cvt_pk_bf16_f32 v27, v28, v29
v_lshlrev_b32 v28, 16, v27
v_and_b32 v29, s66, v27
v_pk_mul_f32 v[30:31], v[28:29], v[28:29]
v_pk_fma_f32 v[30:31], v[30:31], v[8:9], v[10:11]
v_pk_mul_f32 v[30:31], v[30:31], v[28:29]
v_exp_f32 v30, v30
v_exp_f32 v31, v31
s_nop 0
v_pk_add_f32 v[30:31], v[30:31], v[12:13]
v_rcp_f32 v30, v30
v_rcp_f32 v31, v31
s_nop 0
v_pk_mul_f32 v[30:31], v[30:31], v[28:29]
v_cvt_pk_bf16_f32 v27, v30, v31
v_dot2c_f32_bf16 v26, v27, v119
s_nop 2
v_add_f32_dpp v26, v26, v26 row_ror:8 row_mask:0xf bank_mask:0xf
s_nop 1
v_add_f32_dpp v26, v26, v26 row_ror:4 row_mask:0xf bank_mask:0xf
s_nop 1
v_add_f32_dpp v26, v26, v26 row_ror:2 row_mask:0xf bank_mask:0xf
s_nop 1
v_add_f32_dpp v26, v26, v26 row_ror:1 row_mask:0xf bank_mask:0xf
v_mov_b32 v3, v26
s_nop 1
v_permlane16_swap_b32 v26, v3
v_add_f32 v26, v26, v3
v_mov_b32 v3, v26
s_nop 1
v_permlane32_swap_b32 v26, v3
v_add_f32 v26, v26, v3
v_cmp_eq_u32 vcc, s61, v1
s_nop 1
v_cndmask_b32 v25, v25, v26, vcc
s_add_u32 s61, s61, 1
s_cmp_lt_u32 s61, 16
s_cbranch_scc1 L_hloop
v_cvt_pk_bf16_f32 v3, v25, v25
v_lshlrev_b32 v25, 16, v3
v_add_f32 v25, v25, v20
v_cvt_pk_bf16_f32 v3, v25, v25
v_lshlrev_b32 v25, 16, v3
v_mul_f32 v25, v22, v25
v_cvt_pk_bf16_f32 v3, v25, v25
v_lshlrev_b32 v25, 16, v3
s_lshl_b32 s6, s5, 11
s_lshl_b32 s7, s4, 6
s_add_u32 s6, s6, s7
s_add_u32 s6, s6, 524288
s_add_u32 s14, s42, s6
s_addc_u32 s15, s43, 0
s_lshl_b32 s6, s2, 2
s_add_u32 s6, s6, 540672
s_add_u32 s12, s42, s6
s_addc_u32 s13, s43, 0
s_lshl_b32 s6, s2, 11
s_add_u32 s8, s42, s6
s_addc_u32 s9, s43, 0
v_mov_b32 v28, -1
v_mov_b32 v29, -1
v_mov_b32 v30, -1
v_mov_b32 v31, -1
global_store_dwordx4 v2, v[28:31], s[8:9] sc1
global_store_dwordx4 v2, v[28:31], s[8:9] offset:1024 sc1
v_lshlrev_b32 v3, 2, v1
s_mov_b64 exec, 0xffff
global_store_dword v3, v25, s[14:15] sc1
s_mov_b64 exec, 1
global_store_dword v3, v21, s[12:13] sc1
s_mov_b64 exec, -1
s_waitcnt vmcnt(0)
s_barrier
L_end:
s_endpgm
.section .rodata,"a"
.p2align 6
.amdhsa_kernel gated_mix__mha_block_cached__mixer_token_mlp__decode_kernel
  .amdhsa_next_free_vgpr 168
  .amdhsa_next_free_sgpr 102
  .amdhsa_accum_offset 168
  .amdhsa_group_segment_fixed_size 0
  .amdhsa_kernarg_size 112
  .amdhsa_user_sgpr_count 2
  .amdhsa_user_sgpr_kernarg_segment_ptr 1
  .amdhsa_system_sgpr_workgroup_id_x 1
  .amdhsa_float_denorm_mode_32 3
.end_amdhsa_kernel
```
